```python
import torch

def _softmax(x, axis=-1):
    return torch.softmax(x, dim=axis)
def _gelu(x):
    return torch.nn.functional.gelu(x, approximate="tanh")
def _silu(x):
    return torch.nn.functional.silu(x)
def _sigmoid(x):
    return torch.sigmoid(x)
def _layernorm(x, axis=-1, eps=1e-5):
    m = x.mean(dim=axis, keepdim=True)
    v = x.var(dim=axis, keepdim=True, unbiased=False)
    return (x - m) / torch.sqrt(v + eps)
def _scatter_add(tgt, idx, src, axis=0):
    return tgt.clone().index_add_(axis, idx, src)
def _segment_sum(src, seg, n):
    out = torch.zeros((n,) + src.shape[1:], dtype=src.dtype)
    return out.index_add_(0, seg, src)
def _pad(x, pw):
    flat = tuple(v for pair in reversed(pw) for v in pair)
    return torch.nn.functional.pad(x, flat)

kernel_name = 'standalone__cross_network_dcn_v2__recsys'

def setup_inputs():

    _w = (lambda a: (lambda t: t.to(torch.bfloat16) if t.is_floating_point() else t)(torch.as_tensor(a)))
    B, F, D, L = 16384, 26, 16, 6
    Din = min(F * D, 512)
    R = max(Din // 4, 2)
    sc = Din ** -0.5
    return {
        "x0": _w((lambda *s: torch.randn(*s, dtype=torch.bfloat16) * 0.05)(B, Din)),
        "U":  _w((lambda *s: torch.randn(*s, dtype=torch.bfloat16) * 1.6)(L, Din, R) * sc),
        "V":  _w((lambda *s: torch.randn(*s, dtype=torch.bfloat16) * 1.6)(L, R, Din) * sc),
        "bs": _w((lambda *s: torch.randn(*s, dtype=torch.bfloat16) * 0.05)(L, Din)),
    }

def reference(x0, U, V, bs):
    x = x0
    for l in range(U.shape[0]):
        h = torch.einsum('rd,bd->br', V[l], x)
        h = torch.einsum('dr,br->bd', U[l], h)
        x = x0 * (h + bs[l]) + x
    return x
```

```asm
; @launch grid=(256,1,1) block=(256,1,1) lds=139264
.amdgcn_target "amdgcn-amd-amdhsa--gfx950"
.text
.globl standalone__cross_network_dcn_v2__recsys_kernel
.p2align 8
.type standalone__cross_network_dcn_v2__recsys_kernel,@function
standalone__cross_network_dcn_v2__recsys_kernel:
  s_cmp_ge_u32 s2, 256
  s_cbranch_scc1 L_end
  s_load_dwordx2 s[16:17], s[0:1], 16
  s_load_dwordx2 s[8:9], s[0:1], 0
  s_load_dwordx2 s[12:13], s[0:1], 8
  s_load_dwordx2 s[20:21], s[0:1], 24
  s_load_dwordx2 s[24:25], s[0:1], 32
  v_lshrrev_b32 v209, 6, v0
  v_and_b32 v208, 63, v0
  v_readfirstlane_b32 s32, v209
  s_getpc_b64 s[28:29]
L_pc:
  s_mov_b32 s30, L_pad-L_pc
  s_mov_b32 s31, 0x20000
  s_lshr_b32 s4, s2, 3
  s_and_b32 s4, s4, 15
  s_lshl_b32 s4, s4, 2
  s_add_u32 s4, s4, s32
  s_mul_i32 s4, s4, 512
  v_lshlrev_b32 v228, 6, v208
  s_mov_b64 exec, 0xff
  buffer_load_dword a80, v228, s[28:31], s4 offen
  s_mov_b64 exec, -1
  v_lshrrev_b32 v210, 4, v208
  v_and_b32 v211, 15, v208
  v_lshrrev_b32 v212, 3, v208
  v_and_b32 v213, 7, v208
  v_mul_u32_u24 v214, 1664, v212
  v_lshrrev_b32 v215, 1, v212
  v_xor_b32 v215, v215, v213
  v_lshl_add_u32 v253, v215, 4, v214
  s_and_b32 s49, s32, 1
  s_lshr_b32 s50, s32, 1
  s_mul_i32 s33, s49, 6656
  s_mul_i32 s51, s50, 1088
  s_add_u32 s33, s33, s51
  s_mul_i32 s34, s49, 896
  s_mul_i32 s51, s50, 13312
  s_add_u32 s34, s34, s51
  s_add_u32 s35, s34, 26624
  s_add_u32 s36, s34, 53248
  s_mov_b32 s18, 519168
  s_mov_b32 s19, 0x20000
  s_waitcnt lgkmcnt(0)
  s_add_u32 m0, s33, 6656
  s_nop 0
  buffer_load_dwordx4 v253, s[16:19], s34 offen offset:0 lds
  s_add_u32 m0, s33, 8768
  s_nop 0
  buffer_load_dwordx4 v253, s[16:19], s35 offen offset:0 lds
  s_mul_i32 s37, s32, 13312
  s_mul_i32 s38, s50, 6656
  s_mul_i32 s51, s49, 1088
  s_add_u32 s38, s38, s51
  s_add_u32 s38, s38, 90304
  s_mul_i32 s39, s49, 13312
  s_add_u32 s39, s39, 53248
  s_add_u32 s40, s51, 103616
  s_add_u32 m0, s33, 10880
  s_nop 0
  buffer_load_dwordx4 v253, s[16:19], s36 offen offset:0 lds
  s_mov_b32 m0, s38
  s_nop 0
  buffer_load_dwordx4 v253, s[16:19], s37 offen offset:768 lds
  v_lshlrev_b32 v254, 4, v208
  s_lshl_b32 s52, s32, 10
  s_add_u32 s42, s52, 131008
  s_add_u32 s92, s52, 79872
  s_min_u32 s94, s32, 2
  s_lshl_b32 s94, s94, 10
  s_add_u32 s93, s94, 83968
  s_add_u32 s94, s94, 135104
  s_mov_b32 m0, s40
  s_nop 0
  buffer_load_dwordx4 v253, s[16:19], s39 offen offset:768 lds
  s_mov_b32 m0, s42
  s_nop 0
  buffer_load_dwordx4 v254, s[16:19], s92 offen lds
  v_mul_u32_u24 v248, 832, v211
  v_lshl_add_u32 v248, v210, 4, v248
  s_lshl_b32 s48, s2, 2
  s_add_u32 s48, s48, s32
  s_mul_i32 s48, s48, 13312
  s_mov_b32 s10, 13631488
  s_mov_b32 s11, 0x20000
  s_mov_b32 m0, s94
  s_nop 0
  buffer_load_dwordx4 v254, s[16:19], s93 offen lds
  buffer_load_dwordx4 v[108:111], v248, s[8:11], s48 offen offset:0
  v_min_u32 v216, 5, v212
  v_mul_u32_u24 v218, 832, v216
  v_lshl_add_u32 v218, v213, 3, v218
  s_lshl_b32 s95, s32, 6
  s_add_u32 s46, s52, 81920
  s_add_u32 s41, s52, 166400
  s_add_u32 s43, s52, 170496
  s_add_u32 s44, s52, 135104
  s_lshr_b32 s4, s2, 3
  s_and_b32 s4, s4, 31
  s_lshl_b32 s4, s4, 2
  s_add_u32 s4, s4, s32
  s_mul_i32 s4, s4, 676
  s_and_b32 s4, s4, 0xffffffc0
  s_add_u32 s5, s4, 86528
  s_add_u32 s6, s4, 173056
  s_mov_b32 s14, 519168
  s_mov_b32 s15, 0x20000
  s_mov_b32 s22, 4992
  s_mov_b32 s23, 0x20000
  s_mov_b32 s26, 13631488
  s_mov_b32 s27, 0x20000
  v_mul_u32_u24 v216, 336, v216
  v_lshl_add_u32 v216, v213, 4, v216
  v_add_u32 v216, 87040, v216
  s_mul_i32 s49, s32, 6656
  v_add_u32 v16, s49, v216
  s_add_u32 s50, s49, 26624
  s_cmp_eq_u32 s32, 3
  s_cselect_b32 s50, 2016, s50
  v_add_u32 v17, s50, v216
  s_add_u32 s50, s49, 8672
  v_add_u32 v18, s50, v216
  v_add_u32 v19, 35296, v216
  v_mov_b32 v9, 0
  v_mov_b32 v11, 0
  v_mov_b32 v13, 0
  v_mov_b32 v15, 0
  s_lshl_b32 s45, s32, 12
  s_cmp_eq_u32 s32, 3
  s_cselect_b32 s43, 86016, s43
  s_cselect_b32 s44, 86016, s44
  s_cselect_b32 s28, s12, s16
  s_cselect_b32 s29, s13, s17
  s_mov_b32 s30, 519168
  s_mov_b32 s31, 0x20000
  s_mov_b32 s54, 0
  s_mov_b32 s55, -1
  s_mov_b32 s47, 4
  v_lshrrev_b32 v214, 2, v211
  buffer_load_dwordx4 v[116:119], v248, s[8:11], s48 offen offset:64
  v_and_b32 v215, 3, v211
  v_lshlrev_b32 v214, 2, v214
  v_add_u32 v214, v214, v215
  v_lshlrev_b32 v221, 1, v214
  v_and_b32 v214, 7, v211
  v_lshrrev_b32 v215, 1, v214
  v_xor_b32 v215, v215, v210
  v_lshlrev_b32 v215, 4, v215
  v_lshl_add_u32 v215, v214, 7, v215
  v_lshrrev_b32 v214, 3, v211
  v_mul_u32_u24 v214, 1088, v214
  v_add_u32 v215, v215, v214
  v_add_u32 v249, 46592, v215
  v_lshrrev_b32 v214, 3, v211
  v_mul_u32_u24 v214, 12, v214
  v_xor_b32 v214, v214, v211
  v_mul_u32_u24 v214, 832, v214
  v_lshl_add_u32 v214, v210, 4, v214
  v_add_u32 v250, 131008, v214
  v_add_u32 v214, 2, v210
  v_and_b32 v214, 3, v214
  v_lshlrev_b32 v214, 4, v214
  v_add_u32 v214, 138240, v214
  v_cmp_gt_u32 vcc, 8, v211
  v_lshlrev_b32 v215, 2, v208
  s_lshl_b32 s49, s32, 8
  v_cndmask_b32 v250, v214, v250, vcc
  s_add_u32 s49, s49, 138240
  buffer_load_dword a78, v254, s[16:19], s4 offen
  v_mov_b32 v214, 0
  v_add_u32 v215, s49, v215
  ds_write_b32 v215, v214
  v_mul_u32_u24 v214, 208, v221
  v_lshl_add_u32 v251, v210, 4, v214
  v_lshl_add_u32 v214, v210, 3, v214
  v_add_u32 v214, 192, v214
  v_lshlrev_b32 v215, 3, v211
  v_add_u32 v215, 87040, v215
  v_cndmask_b32_e64 v252, v214, v215, s[54:55]
  v_mov_b32 v214, 46592
  v_mov_b32 v215, 2016
  v_cndmask_b32_e64 v255, v214, v215, s[54:55]
  v_mov_b32 v214, 4294920704
  v_mov_b32 v215, 4294965616
  v_cndmask_b32_e64 v214, v214, v215, s[54:55]
  v_accvgpr_write_b32 a77, v214
  v_and_b32 v214, 1, v208
  v_mul_u32_u24 v215, 768, v214
  v_sub_u32 v215, v248, v215
  v_add_u32 v215, 768, v215
  v_accvgpr_write_b32 a76, v215
  v_mul_u32_u24 v215, 896, v214
  v_sub_u32 v215, v248, v215
  v_add_u32 v215, 64, v215
  v_accvgpr_write_b32 a81, v215
  v_accvgpr_write_b32 a54, 0
  v_accvgpr_write_b32 a55, 0
  buffer_load_dwordx2 v[0:1], v218, s[20:23], s95 offen offset:0
  v_accvgpr_write_b32 a58, 0
  v_accvgpr_write_b32 a59, 0
  v_accvgpr_write_b32 a62, 0
  v_accvgpr_write_b32 a63, 0
  v_accvgpr_write_b32 a66, 0
  v_accvgpr_write_b32 a67, 0
  v_accvgpr_write_b32 a70, 0
  v_accvgpr_write_b32 a71, 0
  v_accvgpr_write_b32 a74, 0
  v_accvgpr_write_b32 a75, 0
  v_mov_b32 v20, 1.0
  v_mov_b32 v21, 1.0
  v_mov_b32 v22, 1.0
  v_mov_b32 v23, 1.0
  v_mov_b32 v24, 1.0
  v_mov_b32 v25, 1.0
  v_mov_b32 v26, 1.0
  v_mov_b32 v27, 1.0
  v_mov_b32 v28, 1.0
  v_mov_b32 v29, 1.0
  v_mov_b32 v30, 1.0
  v_mov_b32 v31, 1.0
  v_mov_b32 v32, 1.0
  v_mov_b32 v33, 1.0
  v_mov_b32 v34, 1.0
  v_mov_b32 v35, 1.0
  v_mov_b32 v36, 1.0
  v_mov_b32 v37, 1.0
  buffer_load_dwordx2 v[2:3], v218, s[20:23], s95 offen offset:256
  v_mov_b32 v38, 1.0
  v_mov_b32 v39, 1.0
  v_mov_b32 v40, 1.0
  v_mov_b32 v41, 1.0
  v_mov_b32 v42, 1.0
  v_mov_b32 v43, 1.0
  v_mov_b32 v44, 1.0
  v_mov_b32 v45, 1.0
  v_mov_b32 v46, 1.0
  v_mov_b32 v47, 1.0
  v_mov_b32 v48, 1.0
  v_mov_b32 v49, 1.0
  v_mov_b32 v50, 1.0
  v_mov_b32 v51, 1.0
  v_mov_b32 v52, 1.0
  v_mov_b32 v53, 1.0
  v_mov_b32 v54, 1.0
  v_mov_b32 v55, 1.0
  v_mov_b32 v56, 1.0
  v_mov_b32 v57, 1.0
  v_mov_b32 v58, 1.0
  v_mov_b32 v59, 1.0
  v_mov_b32 v60, 1.0
  v_mov_b32 v61, 1.0
  v_mov_b32 v62, 1.0
  v_mov_b32 v63, 1.0
  v_mov_b32 v64, 1.0
  v_mov_b32 v65, 1.0
  buffer_load_dwordx2 v[4:5], v218, s[20:23], s95 offen offset:512
  v_mov_b32 v66, 1.0
  v_mov_b32 v67, 1.0
  v_mov_b32 v68, 1.0
  v_mov_b32 v69, 1.0
  v_mov_b32 v70, 1.0
  v_mov_b32 v71, 1.0
  v_mov_b32 v72, 1.0
  v_mov_b32 v73, 1.0
  v_mov_b32 v74, 1.0
  v_mov_b32 v75, 1.0
  v_mov_b32 v76, 1.0
  v_mov_b32 v77, 1.0
  v_mov_b32 v78, 1.0
  v_mov_b32 v79, 1.0
  v_mov_b32 v80, 1.0
  v_mov_b32 v81, 1.0
  v_mov_b32 v82, 1.0
  v_mov_b32 v83, 1.0
  v_mov_b32 v84, 1.0
  v_mov_b32 v85, 1.0
  v_mov_b32 v86, 1.0
  v_mov_b32 v87, 1.0
  v_mov_b32 v88, 1.0
  v_mov_b32 v89, 1.0
  v_mov_b32 v90, 1.0
  v_mov_b32 v91, 1.0
  v_mov_b32 v92, 1.0
  v_mov_b32 v93, 1.0
  buffer_load_dwordx2 v[6:7], v218, s[20:23], 0 offen offset:768
  v_mov_b32 v94, 1.0
  v_mov_b32 v95, 1.0
  v_mov_b32 v96, 1.0
  v_mov_b32 v97, 1.0
  v_mov_b32 v98, 1.0
  v_mov_b32 v99, 1.0
  v_mov_b32 v100, 1.0
  v_mov_b32 v101, 1.0
  v_mov_b32 v102, 1.0
  v_mov_b32 v103, 1.0
  s_add_u32 m0, s33, 19840
  s_nop 0
  buffer_load_dwordx4 v253, s[16:19], s34 offen offset:128 lds
  s_add_u32 m0, s33, 21952
  s_nop 0
  buffer_load_dwordx4 v253, s[16:19], s35 offen offset:128 lds
  s_add_u32 m0, s33, 24064
  s_nop 0
  buffer_load_dwordx4 v253, s[16:19], s36 offen offset:128 lds
  buffer_load_dwordx4 v[124:127], v248, s[8:11], s48 offen offset:128
  buffer_load_dwordx4 v[132:135], v248, s[8:11], s48 offen offset:192
  buffer_load_dwordx4 v[140:143], v248, s[8:11], s48 offen offset:256
  s_add_u32 m0, s33, 33024
  s_nop 0
  buffer_load_dwordx4 v253, s[16:19], s34 offen offset:256 lds
  s_add_u32 m0, s33, 35136
  s_nop 0
  buffer_load_dwordx4 v253, s[16:19], s35 offen offset:256 lds
  s_add_u32 m0, s33, 37248
  s_nop 0
  buffer_load_dwordx4 v253, s[16:19], s36 offen offset:256 lds
  buffer_load_dwordx4 v[148:151], v248, s[8:11], s48 offen offset:320
  buffer_load_dwordx4 v[156:159], v248, s[8:11], s48 offen offset:384
  buffer_load_dwordx4 v[164:167], v248, s[8:11], s48 offen offset:448
  buffer_load_dwordx4 v[172:175], v248, s[8:11], s48 offen offset:512
  buffer_load_dwordx4 v[180:183], v248, s[8:11], s48 offen offset:576
  buffer_load_dwordx4 v[240:243], v248, s[8:11], s48 offen offset:640
  buffer_load_dwordx4 v[244:247], v248, s[8:11], s48 offen offset:704
  buffer_load_dwordx4 v[236:239], v248, s[8:11], s48 offen offset:768
  s_branch L_p2
.p2align 12
L_p2:
  s_waitcnt vmcnt(17)
  v_lshlrev_b32 v8, 16, v0
  v_lshlrev_b32 v10, 16, v1
  v_and_b32 v12, 0xffff0000, v0
  v_and_b32 v14, 0xffff0000, v1
  ds_write_b128 v16, v[8:11]
  ds_write_b128 v16, v[12:15] offset:208
  v_lshlrev_b32 v8, 16, v2
  v_lshlrev_b32 v10, 16, v3
  v_and_b32 v12, 0xffff0000, v2
  v_and_b32 v14, 0xffff0000, v3
  ds_write_b128 v17, v[8:11]
  ds_write_b128 v17, v[12:15] offset:208
  v_lshlrev_b32 v8, 16, v4
  v_lshlrev_b32 v10, 16, v5
  v_and_b32 v12, 0xffff0000, v4
  v_and_b32 v14, 0xffff0000, v5
  ds_write_b128 v18, v[8:11]
  ds_write_b128 v18, v[12:15] offset:208
  v_lshlrev_b32 v8, 16, v6
  v_lshlrev_b32 v10, 16, v7
  v_and_b32 v12, 0xffff0000, v6
  v_and_b32 v14, 0xffff0000, v7
  ds_write_b128 v19, v[8:11]
  ds_write_b128 v19, v[12:15] offset:208
  v_mov_b32 v0, 1.0
  v_mov_b32 v1, 1.0
  v_mov_b32 v2, 1.0
  v_mov_b32 v3, 1.0
  v_mov_b32 v4, 1.0
  v_mov_b32 v5, 1.0
  v_mov_b32 v6, 1.0
  v_mov_b32 v7, 1.0
  v_mov_b32 v8, 1.0
  v_mov_b32 v9, 1.0
  v_mov_b32 v10, 1.0
  v_mov_b32 v11, 1.0
  v_mov_b32 v12, 1.0
  v_mov_b32 v13, 1.0
  v_mov_b32 v14, 1.0
  v_mov_b32 v15, 1.0
  v_mov_b32 v16, 1.0
  v_mov_b32 v17, 1.0
  v_mov_b32 v18, 1.0
  v_mov_b32 v19, 1.0
  s_mov_b64 exec, 0
  s_cmp_eq_u32 s32, 0
  s_cbranch_scc1 L_tA
  s_cmp_eq_u32 s32, 1
  s_cbranch_scc1 L_tB
  s_cmp_eq_u32 s32, 2
  s_cbranch_scc1 L_tret
  s_branch L_tret
L_tret:
  s_mov_b64 exec, -1
  s_waitcnt vmcnt(23) lgkmcnt(0)
  s_barrier
  ds_read_b128 a[0:3], v249 offset:44544
  ds_read_b128 a[4:7], v249 offset:51200
  ds_read_b128 a[8:11], v249 offset:57856
  v_subrev_u32 v249, 46592, v249
  ds_read_b128 a[12:15], v249 offset:6656
  ds_read_b128 a[16:19], v249 offset:8768
  ds_read_b128 a[20:23], v249 offset:10880
  ds_read_b128 a[24:27], v250 offset:0
  ds_read_b128 a[28:31], v250 offset:64
  ds_read_b128 a[32:35], v249 offset:17536
  ds_read_b128 a[36:39], v249 offset:10944
  ds_read_b128 a[40:43], v249 offset:15424
  ds_read_b128 a[44:47], v249 offset:8832
  s_waitcnt lgkmcnt(10)
  v_mfma_f32_16x16x32_bf16 v[212:215], a[0:3], v[108:111], 0
  s_add_u32 m0, s33, 46208
  ds_read_b128 a[48:51], v249 offset:13312
  buffer_load_dwordx4 v253, s[16:19], s34 offen offset:384 lds
  v_mfma_f32_16x16x32_bf16 v[220:223], a[4:7], v[108:111], 0
  s_waitcnt vmcnt(15) lgkmcnt(8)
  ds_read_b128 a[0:3], v249 offset:6720
  v_mfma_f32_16x16x32_bf16 v[228:231], a[8:11], v[108:111], 0
  s_barrier
  ds_read_b128 a[4:7], v249 offset:19968
  v_mfma_f32_16x16x32_bf16 v[208:211], a[12:15], v[108:111], 0
  s_add_u32 m0, s33, 48320
  ds_read_b128 a[8:11], v249 offset:13376
  buffer_load_dwordx4 v253, s[16:19], s35 offen offset:384 lds
  v_mfma_f32_16x16x32_bf16 v[216:219], a[16:19], v[108:111], 0
  s_waitcnt lgkmcnt(9)
  ds_read_b128 a[12:15], v249 offset:22080
  v_mfma_f32_16x16x32_bf16 v[224:227], a[20:23], v[108:111], 0
  s_add_u32 m0, s33, 50432
  ds_read_b128 a[16:19], v249 offset:15488
  v_mfma_f32_16x16x32_bf16 v[232:235], a[24:27], v[108:111], 0
  s_waitcnt vmcnt(24) lgkmcnt(7)
  ds_read_b128 a[20:23], v249 offset:24192
  buffer_load_dwordx4 v253, s[16:19], s36 offen offset:384 lds
  v_mfma_f32_16x16x32_bf16 v[232:235], a[28:31], v[116:119], v[232:235]
  ds_read_b128 a[24:27], v249 offset:17600
  v_lshlrev_b32 v104, 16, v108
  v_mfma_f32_16x16x32_bf16 v[228:231], a[32:35], v[116:119], v[228:231]
  ds_read_b128 a[28:31], v250 offset:128
  v_and_b32 v108, 0xffff0000, v108
  v_lshlrev_b32 v105, 16, v109
  v_mfma_f32_16x16x32_bf16 v[224:227], a[36:39], v[116:119], v[224:227]
  s_add_u32 m0, s33, 59392
  ds_read_b128 a[32:35], v250 offset:192
  buffer_load_dwordx4 v253, s[16:19], s34 offen offset:512 lds
  v_mfma_f32_16x16x32_bf16 v[220:223], a[40:43], v[116:119], v[220:223]
  s_waitcnt lgkmcnt(8)
  ds_read_b128 a[36:39], v249 offset:30848
  v_and_b32 v109, 0xffff0000, v109
  v_lshlrev_b32 v106, 16, v110
  v_mfma_f32_16x16x32_bf16 v[216:219], a[44:47], v[116:119], v[216:219]
  ds_read_b128 a[40:43], v249 offset:24256
  v_and_b32 v110, 0xffff0000, v110
  v_mfma_f32_16x16x32_bf16 v[212:215], a[48:51], v[116:119], v[212:215]
  s_add_u32 m0, s33, 61504
  ds_read_b128 a[44:47], v249 offset:28736
  buffer_load_dwordx4 v253, s[16:19], s35 offen offset:512 lds
  v_lshlrev_b32 v107, 16, v111
  v_mfma_f32_16x16x32_bf16 v[208:211], a[0:3], v[116:119], v[208:211]
  s_waitcnt vmcnt(13) lgkmcnt(7)
  ds_read_b128 a[48:51], v249 offset:22144
  v_and_b32 v111, 0xffff0000, v111
  v_mfma_f32_16x16x32_bf16 v[208:211], a[4:7], v[124:127], v[208:211]
  s_barrier
  ds_read_b128 a[0:3], v249 offset:26624
  v_lshlrev_b32 v112, 16, v116
  v_mfma_f32_16x16x32_bf16 v[212:215], a[8:11], v[124:127], v[212:215]
  s_add_u32 m0, s33, 63616
  ds_read_b128 a[4:7], v249 offset:20032
  buffer_load_dwordx4 v253, s[16:19], s36 offen offset:512 lds
  v_and_b32 v116, 0xffff0000, v116
  v_mfma_f32_16x16x32_bf16 v[216:219], a[12:15], v[124:127], v[216:219]
  ds_read_b128 a[8:11], v249 offset:33280
  v_lshlrev_b32 v113, 16, v117
  v_mfma_f32_16x16x32_bf16 v[220:223], a[16:19], v[124:127], v[220:223]
  s_waitcnt lgkmcnt(8)
  ds_read_b128 a[12:15], v249 offset:26688
  v_and_b32 v117, 0xffff0000, v117
  v_lshlrev_b32 v114, 16, v118
  v_mfma_f32_16x16x32_bf16 v[224:227], a[20:23], v[124:127], v[224:227]
  s_add_u32 m0, s33, 72576
  ds_read_b128 a[16:19], v249 offset:35392
  buffer_load_dwordx4 v253, s[16:19], s34 offen offset:640 lds
  v_mfma_f32_16x16x32_bf16 v[228:231], a[24:27], v[124:127], v[228:231]
  ds_read_b128 a[20:23], v249 offset:28800
  v_and_b32 v118, 0xffff0000, v118
  v_lshlrev_b32 v115, 16, v119
  v_mfma_f32_16x16x32_bf16 v[232:235], a[28:31], v[124:127], v[232:235]
  s_waitcnt vmcnt(19) lgkmcnt(8)
  ds_read_b128 a[24:27], v249 offset:37504
  v_and_b32 v119, 0xffff0000, v119
  v_mfma_f32_16x16x32_bf16 v[232:235], a[32:35], v[132:135], v[232:235]
  s_add_u32 m0, s33, 74688
  ds_read_b128 a[28:31], v249 offset:30912
  buffer_load_dwordx4 v253, s[16:19], s35 offen offset:640 lds
  v_mfma_f32_16x16x32_bf16 v[228:231], a[36:39], v[132:135], v[228:231]
  ds_read_b128 a[32:35], v250 offset:256
  v_lshlrev_b32 v120, 16, v124
  v_and_b32 v124, 0xffff0000, v124
  v_mfma_f32_16x16x32_bf16 v[224:227], a[40:43], v[132:135], v[224:227]
  s_waitcnt lgkmcnt(7)
  ds_read_b128 a[36:39], v250 offset:320
  v_lshlrev_b32 v121, 16, v125
  v_mfma_f32_16x16x32_bf16 v[220:223], a[44:47], v[132:135], v[220:223]
  s_add_u32 m0, s33, 76800
  ds_read_b128 a[40:43], v249 offset:44160
  buffer_load_dwordx4 v253, s[16:19], s36 offen offset:640 lds
  v_and_b32 v125, 0xffff0000, v125
  v_mfma_f32_16x16x32_bf16 v[216:219], a[48:51], v[132:135], v[216:219]
  ds_read_b128 a[44:47], v249 offset:37568
  v_lshlrev_b32 v122, 16, v126
  v_mfma_f32_16x16x32_bf16 v[212:215], a[0:3], v[132:135], v[212:215]
  ds_read_b128 a[48:51], v249 offset:42048
  v_and_b32 v126, 0xffff0000, v126
  v_lshlrev_b32 v123, 16, v127
  v_mfma_f32_16x16x32_bf16 v[208:211], a[4:7], v[132:135], v[208:211]
  s_waitcnt vmcnt(6) lgkmcnt(7)
  ds_read_b128 a[0:3], v249 offset:35456
  v_and_b32 v127, 0xffff0000, v127
  v_mfma_f32_16x16x32_bf16 v[208:211], a[8:11], v[140:143], v[208:211]
  s_barrier
  ds_read_b128 a[4:7], v249 offset:39936
  v_lshlrev_b32 v128, 16, v132
  v_mfma_f32_16x16x32_bf16 v[212:215], a[12:15], v[140:143], v[212:215]
  s_add_u32 m0, s45, 0
  ds_read_b128 a[8:11], v249 offset:33344
  buffer_load_dwordx4 v254, s[12:15], m0 offen offset:0 lds
  v_and_b32 v132, 0xffff0000, v132
  v_mfma_f32_16x16x32_bf16 v[216:219], a[16:19], v[140:143], v[216:219]
  ds_read_b128 a[12:15], v249 offset:46592
  v_lshlrev_b32 v129, 16, v133
  v_mfma_f32_16x16x32_bf16 v[220:223], a[20:23], v[140:143], v[220:223]
  s_waitcnt lgkmcnt(8)
  ds_read_b128 a[16:19], v249 offset:40000
  v_and_b32 v133, 0xffff0000, v133
  v_lshlrev_b32 v130, 16, v134
  v_mfma_f32_16x16x32_bf16 v[224:227], a[24:27], v[140:143], v[224:227]
  ds_read_b128 a[20:23], v249 offset:48704
  buffer_load_dwordx4 v254, s[12:15], m0 offen offset:1024 lds
  v_mfma_f32_16x16x32_bf16 v[228:231], a[28:31], v[140:143], v[228:231]
  ds_read_b128 a[24:27], v249 offset:42112
  v_and_b32 v134, 0xffff0000, v134
  v_lshlrev_b32 v131, 16, v135
  v_mfma_f32_16x16x32_bf16 v[232:235], a[32:35], v[140:143], v[232:235]
  s_waitcnt vmcnt(18) lgkmcnt(7)
  ds_read_b128 a[28:31], v249 offset:50816
  v_and_b32 v135, 0xffff0000, v135
  v_mfma_f32_16x16x32_bf16 v[232:235], a[36:39], v[148:151], v[232:235]
  ds_read_b128 a[32:35], v249 offset:44224
  buffer_load_dwordx4 v254, s[12:15], m0 offen offset:2048 lds
  v_mfma_f32_16x16x32_bf16 v[228:231], a[40:43], v[148:151], v[228:231]
  ds_read_b128 a[36:39], v250 offset:384
  v_lshlrev_b32 v136, 16, v140
  v_and_b32 v140, 0xffff0000, v140
  v_mfma_f32_16x16x32_bf16 v[224:227], a[44:47], v[148:151], v[224:227]
  ds_read_b128 a[40:43], v250 offset:448
  v_lshlrev_b32 v137, 16, v141
  v_mfma_f32_16x16x32_bf16 v[220:223], a[48:51], v[148:151], v[220:223]
  s_waitcnt lgkmcnt(8)
  ds_read_b128 a[44:47], v249 offset:57472
  buffer_load_dwordx4 v254, s[12:15], m0 offen offset:3072 lds
  v_and_b32 v141, 0xffff0000, v141
  v_mfma_f32_16x16x32_bf16 v[216:219], a[0:3], v[148:151], v[216:219]
  ds_read_b128 a[48:51], v249 offset:50880
  v_lshlrev_b32 v138, 16, v142
  v_mfma_f32_16x16x32_bf16 v[212:215], a[4:7], v[148:151], v[212:215]
  ds_read_b128 a[0:3], v249 offset:55360
  v_and_b32 v142, 0xffff0000, v142
  v_lshlrev_b32 v139, 16, v143
  v_mfma_f32_16x16x32_bf16 v[208:211], a[8:11], v[148:151], v[208:211]
  s_waitcnt vmcnt(7) lgkmcnt(7)
  ds_read_b128 a[4:7], v249 offset:48768
  v_and_b32 v143, 0xffff0000, v143
  v_mfma_f32_16x16x32_bf16 v[208:211], a[12:15], v[156:159], v[208:211]
  s_barrier
  ds_read_b128 a[8:11], v249 offset:53248
  v_lshlrev_b32 v144, 16, v148
  v_and_b32 v148, 0xffff0000, v148
  v_mfma_f32_16x16x32_bf16 v[212:215], a[16:19], v[156:159], v[212:215]
  s_add_u32 m0, s45, 16384
  ds_read_b128 a[12:15], v249 offset:46656
  buffer_load_dwordx4 v254, s[12:15], m0 offen offset:0 lds
  v_add_u32 v249, 46592, v249
  v_mfma_f32_16x16x32_bf16 v[216:219], a[20:23], v[156:159], v[216:219]
  ds_read_b128 a[16:19], v249 offset:13312
  v_lshlrev_b32 v145, 16, v149
  v_mfma_f32_16x16x32_bf16 v[220:223], a[24:27], v[156:159], v[220:223]
  s_waitcnt lgkmcnt(8)
  ds_read_b128 a[20:23], v249 offset:6720
  v_and_b32 v149, 0xffff0000, v149
  v_lshlrev_b32 v146, 16, v150
  v_mfma_f32_16x16x32_bf16 v[224:227], a[28:31], v[156:159], v[224:227]
  ds_read_b128 a[24:27], v249 offset:15424
  buffer_load_dwordx4 v254, s[12:15], m0 offen offset:1024 lds
  v_mfma_f32_16x16x32_bf16 v[228:231], a[32:35], v[156:159], v[228:231]
  ds_read_b128 a[28:31], v249 offset:8832
  v_and_b32 v150, 0xffff0000, v150
  v_lshlrev_b32 v147, 16, v151
  v_mfma_f32_16x16x32_bf16 v[232:235], a[36:39], v[156:159], v[232:235]
  s_waitcnt vmcnt(20) lgkmcnt(7)
  ds_read_b128 a[32:35], v249 offset:17536
  v_and_b32 v151, 0xffff0000, v151
  v_mfma_f32_16x16x32_bf16 v[232:235], a[40:43], v[164:167], v[232:235]
  ds_read_b128 a[36:39], v249 offset:10944
  buffer_load_dwordx4 v254, s[12:15], m0 offen offset:2048 lds
  v_lshlrev_b32 v152, 16, v156
  v_mfma_f32_16x16x32_bf16 v[228:231], a[44:47], v[164:167], v[228:231]
  ds_read_b128 a[40:43], v250 offset:512
  v_and_b32 v156, 0xffff0000, v156
  v_mfma_f32_16x16x32_bf16 v[224:227], a[48:51], v[164:167], v[224:227]
  ds_read_b128 a[44:47], v250 offset:576
  v_lshlrev_b32 v153, 16, v157
  v_and_b32 v157, 0xffff0000, v157
  v_mfma_f32_16x16x32_bf16 v[220:223], a[0:3], v[164:167], v[220:223]
  s_waitcnt lgkmcnt(10)
  ds_read_b128 a[48:51], v249 offset:24192
  buffer_load_dwordx4 v254, s[12:15], m0 offen offset:3072 lds
  v_mfma_f32_16x16x32_bf16 v[216:219], a[4:7], v[164:167], v[216:219]
  s_waitcnt vmcnt(8) lgkmcnt(9)
  ds_read_b128 a[0:3], v249 offset:17600
  v_lshlrev_b32 v154, 16, v158
  v_and_b32 v158, 0xffff0000, v158
  buffer_load_dword a84, v254, s[16:19], s5 offen
  v_mfma_f32_16x16x32_bf16 v[212:215], a[8:11], v[164:167], v[212:215]
  s_barrier
  ds_read_b128 a[4:7], v249 offset:22080
  v_lshlrev_b32 v155, 16, v159
  v_mfma_f32_16x16x32_bf16 v[208:211], a[12:15], v[164:167], v[208:211]
  s_waitcnt vmcnt(22) lgkmcnt(7)
  s_add_u32 m0, s45, 32768
  ds_read_b128 a[8:11], v249 offset:15488
  buffer_load_dwordx4 v254, s[12:15], m0 offen offset:0 lds
  v_and_b32 v159, 0xffff0000, v159
  v_mfma_f32_16x16x32_bf16 v[208:211], a[16:19], v[172:175], v[208:211]
  ds_read_b128 a[12:15], v249 offset:19968
  v_lshlrev_b32 v160, 16, v164
  v_mfma_f32_16x16x32_bf16 v[212:215], a[20:23], v[172:175], v[212:215]
  ds_read_b128 a[16:19], v249 offset:13376
  v_and_b32 v164, 0xffff0000, v164
  v_lshlrev_b32 v161, 16, v165
  v_mfma_f32_16x16x32_bf16 v[216:219], a[24:27], v[172:175], v[216:219]
  ds_read_b128 a[20:23], v249 offset:26624
  v_and_b32 v165, 0xffff0000, v165
  v_mfma_f32_16x16x32_bf16 v[220:223], a[28:31], v[172:175], v[220:223]
  s_waitcnt lgkmcnt(8)
  ds_read_b128 a[24:27], v249 offset:20032
  buffer_load_dwordx4 v254, s[12:15], m0 offen offset:1024 lds
  v_mfma_f32_16x16x32_bf16 v[224:227], a[32:35], v[172:175], v[224:227]
  ds_read_b128 a[28:31], v249 offset:28736
  v_lshlrev_b32 v162, 16, v166
  v_mfma_f32_16x16x32_bf16 v[228:231], a[36:39], v[172:175], v[228:231]
  ds_read_b128 a[32:35], v249 offset:22144
  v_and_b32 v166, 0xffff0000, v166
  v_lshlrev_b32 v163, 16, v167
  v_mfma_f32_16x16x32_bf16 v[232:235], a[40:43], v[172:175], v[232:235]
  s_waitcnt vmcnt(23) lgkmcnt(7)
  ds_read_b128 a[36:39], v249 offset:30848
  v_and_b32 v167, 0xffff0000, v167
  v_mfma_f32_16x16x32_bf16 v[232:235], a[44:47], v[180:183], v[232:235]
  ds_read_b128 a[40:43], v249 offset:24256
  buffer_load_dwordx4 v254, s[12:15], m0 offen offset:2048 lds
  v_mfma_f32_16x16x32_bf16 v[228:231], a[48:51], v[180:183], v[228:231]
  ds_read_b128 a[44:47], v250 offset:640
  v_lshlrev_b32 v168, 16, v172
  v_and_b32 v172, 0xffff0000, v172
  v_mfma_f32_16x16x32_bf16 v[224:227], a[0:3], v[180:183], v[224:227]
  ds_read_b128 a[48:51], v250 offset:704
  v_lshlrev_b32 v169, 16, v173
  v_mfma_f32_16x16x32_bf16 v[220:223], a[4:7], v[180:183], v[220:223]
  s_waitcnt lgkmcnt(10)
  ds_read_b128 a[0:3], v249 offset:37504
  v_and_b32 v173, 0xffff0000, v173
  v_lshlrev_b32 v170, 16, v174
  v_mfma_f32_16x16x32_bf16 v[216:219], a[8:11], v[180:183], v[216:219]
  s_waitcnt vmcnt(8) lgkmcnt(9)
  ds_read_b128 a[4:7], v249 offset:30912
  buffer_load_dwordx4 v254, s[12:15], m0 offen offset:3072 lds
  v_mfma_f32_16x16x32_bf16 v[212:215], a[12:15], v[180:183], v[212:215]
  s_barrier
  ds_read_b128 a[8:11], v249 offset:35392
  v_and_b32 v174, 0xffff0000, v174
  v_lshlrev_b32 v171, 16, v175
  v_mfma_f32_16x16x32_bf16 v[208:211], a[16:19], v[180:183], v[208:211]
  s_waitcnt vmcnt(24) lgkmcnt(7)
  ds_read_b128 a[12:15], v249 offset:28800
  v_and_b32 v175, 0xffff0000, v175
  v_mfma_f32_16x16x32_bf16 v[208:211], a[20:23], v[240:243], v[208:211]
  ds_read_b128 a[16:19], v249 offset:33280
  v_lshlrev_b32 v176, 16, v180
  v_lshlrev_b32 v184, 16, v240
  v_and_b32 v188, 0xffff0000, v240
  v_mfma_f32_16x16x32_bf16 v[212:215], a[24:27], v[240:243], v[212:215]
  s_add_u32 m0, s45, 49152
  ds_read_b128 a[20:23], v249 offset:26688
  buffer_load_dwordx4 v254, s[12:15], m0 offen offset:0 lds
  v_and_b32 v180, 0xffff0000, v180
  v_mfma_f32_16x16x32_bf16 v[216:219], a[28:31], v[240:243], v[216:219]
  ds_read_b128 a[24:27], v249 offset:44480
  v_lshlrev_b32 v177, 16, v181
  v_lshlrev_b32 v185, 16, v241
  v_and_b32 v189, 0xffff0000, v241
  v_mfma_f32_16x16x32_bf16 v[220:223], a[32:35], v[240:243], v[220:223]
  s_waitcnt lgkmcnt(8)
  ds_read_b128 a[28:31], v249 offset:33344
  v_and_b32 v181, 0xffff0000, v181
  v_lshlrev_b32 v178, 16, v182
  v_mfma_f32_16x16x32_bf16 v[224:227], a[36:39], v[240:243], v[224:227]
  ds_read_b128 a[32:35], v249 offset:51136
  v_and_b32 v182, 0xffff0000, v182
  v_lshlrev_b32 v186, 16, v242
  v_and_b32 v190, 0xffff0000, v242
  v_mfma_f32_16x16x32_bf16 v[228:231], a[40:43], v[240:243], v[228:231]
  ds_read_b128 a[36:39], v249 offset:35456
  buffer_load_dwordx4 v254, s[12:15], m0 offen offset:1024 lds
  v_lshlrev_b32 v179, 16, v183
  v_mfma_f32_16x16x32_bf16 v[232:235], a[44:47], v[240:243], v[232:235]
  s_waitcnt vmcnt(25) lgkmcnt(7)
  ds_read_b128 a[40:43], v249 offset:57792
  v_and_b32 v183, 0xffff0000, v183
  v_lshlrev_b32 v187, 16, v243
  v_and_b32 v191, 0xffff0000, v243
  v_mfma_f32_16x16x32_bf16 v[232:235], a[48:51], v[244:247], v[232:235]
  ds_read_b128 a[44:47], v249 offset:37568
  v_lshlrev_b32 v192, 16, v244
  v_mfma_f32_16x16x32_bf16 v[228:231], a[0:3], v[244:247], v[228:231]
  ds_read_b128 a[48:51], v250 offset:768
  v_and_b32 v196, 0xffff0000, v244
  v_lshlrev_b32 v193, 16, v245
  v_mfma_f32_16x16x32_bf16 v[224:227], a[4:7], v[244:247], v[224:227]
  ds_read_b128 a[0:3], v251 offset:0
  buffer_load_dwordx4 v254, s[12:15], m0 offen offset:2048 lds
  v_mfma_f32_16x16x32_bf16 v[220:223], a[8:11], v[244:247], v[220:223]
  s_waitcnt lgkmcnt(8)
  ds_read_b128 a[4:7], v251 offset:208
  v_and_b32 v197, 0xffff0000, v245
  v_lshlrev_b32 v194, 16, v246
  v_mfma_f32_16x16x32_bf16 v[216:219], a[12:15], v[244:247], v[216:219]
  ds_read_b128 a[8:11], v251 offset:6656
  v_and_b32 v198, 0xffff0000, v246
  v_mfma_f32_16x16x32_bf16 v[212:215], a[16:19], v[244:247], v[212:215]
  ds_read_b128 a[12:15], v251 offset:6864
  v_lshlrev_b32 v195, 16, v247
  v_and_b32 v199, 0xffff0000, v247
  v_mfma_f32_16x16x32_bf16 v[208:211], a[20:23], v[244:247], v[208:211]
  s_waitcnt vmcnt(25) lgkmcnt(7)
  ds_read_b128 a[16:19], v251 offset:64
  buffer_load_dwordx4 v254, s[12:15], m0 offen offset:3072 lds
  v_mfma_f32_16x16x32_bf16 v[208:211], a[24:27], v[236:239], v[208:211]
  ds_read_b128 a[20:23], v251 offset:272
  v_lshlrev_b32 v200, 16, v236
  v_and_b32 v204, 0xffff0000, v236
  buffer_load_dword a85, v254, s[12:15], s5 offen
  v_mfma_f32_16x16x32_bf16 v[212:215], a[28:31], v[236:239], v[212:215]
  ds_read_b128 a[24:27], v251 offset:6720
  v_lshlrev_b32 v201, 16, v237
  v_and_b32 v205, 0xffff0000, v237
  v_mfma_f32_16x16x32_bf16 v[216:219], a[32:35], v[236:239], v[216:219]
  ds_read_b128 a[28:31], v251 offset:6928
  v_add_u32 v253, 86528, v253
  v_mfma_f32_16x16x32_bf16 v[220:223], a[36:39], v[236:239], v[220:223]
  s_waitcnt lgkmcnt(8)
  ds_read_b128 a[32:35], v251 offset:128
  v_lshlrev_b32 v202, 16, v238
  v_and_b32 v206, 0xffff0000, v238
  v_mfma_f32_16x16x32_bf16 v[224:227], a[40:43], v[236:239], v[224:227]
  ds_read_b128 a[36:39], v251 offset:336
  v_cvt_pk_bf16_f32 v208, v208, v212
  v_cvt_pk_bf16_f32 v209, v209, v213
  v_mfma_f32_16x16x32_bf16 v[228:231], a[44:47], v[236:239], v[228:231]
  ds_read_b128 a[40:43], v251 offset:6784
  v_cvt_pk_bf16_f32 v210, v210, v214
  v_cvt_pk_bf16_f32 v211, v211, v215
  v_mfma_f32_16x16x32_bf16 v[232:235], a[48:51], v[236:239], v[232:235]
  s_waitcnt vmcnt(10) lgkmcnt(7)
  ds_read_b128 a[44:47], v251 offset:6992
  v_lshlrev_b32 v203, 16, v239
  v_and_b32 v207, 0xffff0000, v239
  s_and_b32 s3, s32, 1
  s_cbranch_scc1 L_loop1
  s_branch L_loop0
.p2align 12
L_tA:
  s_branch L_tG
L_loop0:
  v_mfma_f32_16x16x32_bf16 v[0:3], a[0:3], v[208:211], v[0:3]
  s_barrier
  ds_read_b64 a[52:53], v252 offset:0
  v_cvt_pk_bf16_f32 v216, v216, v220
  v_cvt_pk_bf16_f32 v217, v217, v221
  v_mfma_f32_16x16x32_bf16 v[4:7], a[4:7], v[208:211], v[4:7]
  s_add_u32 m0, s45, 65536
  ds_read_b64 a[56:57], v252 offset:208
  buffer_load_dwordx4 v254, s[12:15], m0 offen offset:0 lds
  v_mfma_f32_16x16x32_bf16 v[8:11], a[8:11], v[208:211], v[8:11]
  ds_read_b64 a[60:61], v252 offset:6656
  v_cvt_pk_bf16_f32 v218, v218, v222
  v_cvt_pk_bf16_f32 v219, v219, v223
  v_mfma_f32_16x16x32_bf16 v[12:15], a[12:15], v[208:211], v[12:15]
  s_waitcnt lgkmcnt(7)
  ds_read_b64 a[64:65], v252 offset:6864
  v_cvt_pk_bf16_f32 v224, v224, v228
  v_mfma_f32_16x16x32_bf16 v[0:3], a[16:19], v[216:219], v[0:3]
  ds_read_b128 a[12:15], v251 offset:13312
  v_cvt_pk_bf16_f32 v225, v225, v229
  v_cvt_pk_bf16_f32 v226, v226, v230
  v_mfma_f32_16x16x32_bf16 v[4:7], a[20:23], v[216:219], v[4:7]
  ds_read_b128 a[16:19], v251 offset:13376
  buffer_load_dwordx4 v254, s[12:15], m0 offen offset:1024 lds
  v_mfma_f32_16x16x32_bf16 v[8:11], a[24:27], v[216:219], v[8:11]
  ds_read_b128 a[20:23], v251 offset:13440
  v_cvt_pk_bf16_f32 v227, v227, v231
  v_mfma_f32_16x16x32_bf16 v[12:15], a[28:31], v[216:219], v[12:15]
  s_waitcnt lgkmcnt(7)
  ds_read_b64 a[68:69], v252 offset:13312
  v_cvt_pk_bf16_f32 v232, v232, v233
  v_cvt_pk_bf16_f32 v233, v234, v235
  v_mfma_f32_16x16x32_bf16 v[0:3], a[32:35], v[224:227], v[0:3]
  ds_read_b64 a[72:73], v252 offset:13520
  v_mov_b32 v234, 0
  v_mfma_f32_16x16x32_bf16 v[4:7], a[36:39], v[224:227], v[4:7]
  ds_read_b128 a[32:35], v251 offset:13648
  buffer_load_dwordx4 v254, s[12:15], m0 offen offset:2048 lds
  v_mov_b32 v235, 0
  v_mfma_f32_16x16x32_bf16 v[8:11], a[40:43], v[224:227], v[8:11]
  ds_read_b128 a[36:39], v251 offset:13584
  v_cndmask_b32_e64 v232, v232, 0.5, s[54:55]
  v_mfma_f32_16x16x32_bf16 v[12:15], a[44:47], v[224:227], v[12:15]
  s_waitcnt lgkmcnt(7)
  ds_read_b128 a[40:43], v251 offset:13520
  v_mfma_f32_16x16x32_bf16 v[0:3], a[52:55], v[232:235], v[0:3]
  ds_read_b128 a[44:47], v251 offset:19968
  v_mfma_f32_16x16x32_bf16 v[4:7], a[56:59], v[232:235], v[4:7]
  ds_read_b128 a[48:51], v251 offset:20032
  buffer_load_dwordx4 v254, s[12:15], m0 offen offset:3072 lds
  v_mfma_f32_16x16x32_bf16 v[8:11], a[60:63], v[232:235], v[8:11]
  ds_read_b128 a[0:3], v251 offset:20096
  buffer_load_dword a86, v254, s[16:19], s6 offen
  v_mfma_f32_16x16x32_bf16 v[12:15], a[64:67], v[232:235], v[12:15]
  s_waitcnt lgkmcnt(7)
  ds_read_b64 a[52:53], v252 offset:19968
  v_mfma_f32_16x16x32_bf16 v[16:19], a[12:15], v[208:211], v[16:19]
  ds_read_b64 a[56:57], v252 offset:20176
  v_mfma_f32_16x16x32_bf16 v[16:19], a[16:19], v[216:219], v[16:19]
  s_mov_b32 m0, s46
  ds_read_b128 a[12:15], v251 offset:20304
  buffer_load_dwordx4 v254, s[12:15], m0 offen lds
  v_mfma_f32_16x16x32_bf16 v[16:19], a[20:23], v[224:227], v[16:19]
  ds_read_b128 a[16:19], v251 offset:20240
  v_mul_f32 v236, v104, v0
  v_mfma_f32_16x16x32_bf16 v[16:19], a[68:71], v[232:235], v[16:19]
  s_waitcnt vmcnt(11) lgkmcnt(7)
  ds_read_b128 a[20:23], v251 offset:20176
  v_mul_f32 v248, v108, v4
  v_mfma_f32_16x16x32_bf16 v[20:23], a[72:75], v[232:235], v[20:23]
  s_barrier
  ds_read_b128 a[24:27], v251 offset:26624
  v_mfma_f32_16x16x32_bf16 v[20:23], a[32:35], v[224:227], v[20:23]
  ds_read_b128 a[28:31], v251 offset:26688
  v_cvt_pk_bf16_f32 v236, v236, v248
  v_mfma_f32_16x16x32_bf16 v[20:23], a[36:39], v[216:219], v[20:23]
  s_mov_b32 m0, s44
  ds_read_b128 a[32:35], v251 offset:26752
  buffer_load_dwordx4 v254, s[28:31], s43 offen lds
  v_mfma_f32_16x16x32_bf16 v[20:23], a[40:43], v[208:211], v[20:23]
  s_waitcnt lgkmcnt(7)
  ds_read_b64 a[60:61], v252 offset:26624
  v_mul_f32 v237, v105, v1
  v_mfma_f32_16x16x32_bf16 v[24:27], a[44:47], v[208:211], v[24:27]
  ds_read_b64 a[64:65], v252 offset:26832
  v_mul_f32 v248, v109, v5
  v_mfma_f32_16x16x32_bf16 v[24:27], a[48:51], v[216:219], v[24:27]
  ds_read_b128 a[44:47], v251 offset:26960
  v_cvt_pk_bf16_f32 v237, v237, v248
  v_mfma_f32_16x16x32_bf16 v[24:27], a[0:3], v[224:227], v[24:27]
  s_mov_b32 m0, s42
  ds_read_b128 a[48:51], v251 offset:26896
  buffer_load_dwordx4 v254, s[16:19], s41 offen lds
  v_mfma_f32_16x16x32_bf16 v[24:27], a[52:55], v[232:235], v[24:27]
  s_waitcnt lgkmcnt(7)
  ds_read_b128 a[0:3], v251 offset:26832
  v_mul_f32 v238, v106, v2
  v_mfma_f32_16x16x32_bf16 v[28:31], a[56:59], v[232:235], v[28:31]
  ds_read_b128 a[4:7], v251 offset:33280
  v_mfma_f32_16x16x32_bf16 v[28:31], a[12:15], v[224:227], v[28:31]
  ds_read_b128 a[8:11], v251 offset:33344
  v_mul_f32 v248, v110, v6
  v_mfma_f32_16x16x32_bf16 v[28:31], a[16:19], v[216:219], v[28:31]
  s_mov_b32 m0, s38
  ds_read_b128 a[12:15], v251 offset:33408
  buffer_load_dwordx4 v253, s[16:19], s37 offen offset:768 lds
  v_mfma_f32_16x16x32_bf16 v[28:31], a[20:23], v[208:211], v[28:31]
  s_waitcnt lgkmcnt(7)
  ds_read_b64 a[68:69], v252 offset:33280
  v_cvt_pk_bf16_f32 v238, v238, v248
  v_mfma_f32_16x16x32_bf16 v[32:35], a[24:27], v[208:211], v[32:35]
  ds_read_b64 a[72:73], v252 offset:33488
  v_mul_f32 v239, v107, v3
  v_mfma_f32_16x16x32_bf16 v[32:35], a[28:31], v[216:219], v[32:35]
  ds_read_b128 a[24:27], v251 offset:33616
  v_mul_f32 v248, v111, v7
  v_mfma_f32_16x16x32_bf16 v[32:35], a[32:35], v[224:227], v[32:35]
  s_mov_b32 m0, s40
  ds_read_b128 a[28:31], v251 offset:33552
  buffer_load_dwordx4 v253, s[16:19], s39 offen offset:768 lds
  v_mfma_f32_16x16x32_bf16 v[32:35], a[60:63], v[232:235], v[32:35]
  s_waitcnt lgkmcnt(7)
  ds_read_b128 a[32:35], v251 offset:33488
  v_cvt_pk_bf16_f32 v239, v239, v248
  v_mfma_f32_16x16x32_bf16 v[36:39], a[64:67], v[232:235], v[36:39]
  ds_read_b128 a[36:39], v251 offset:39936
  v_mfma_f32_16x16x32_bf16 v[36:39], a[44:47], v[224:227], v[36:39]
  ds_read_b128 a[40:43], v251 offset:40000
  v_mul_f32 v240, v112, v8
  v_mfma_f32_16x16x32_bf16 v[36:39], a[48:51], v[216:219], v[36:39]
  ds_read_b128 a[44:47], v251 offset:40064
  v_mul_f32 v248, v116, v12
  v_mfma_f32_16x16x32_bf16 v[36:39], a[0:3], v[208:211], v[36:39]
  s_waitcnt vmcnt(10) lgkmcnt(7)
  ds_read_b64 a[52:53], v252 offset:39936
  v_cvt_pk_bf16_f32 v240, v240, v248
  v_mfma_f32_16x16x32_bf16 v[40:43], a[4:7], v[208:211], v[40:43]
  s_barrier
  ds_read_b64 a[56:57], v252 offset:40144
  v_add_u32 v252, v252, v255
  v_mfma_f32_16x16x32_bf16 v[40:43], a[8:11], v[216:219], v[40:43]
  s_add_u32 m0, s33, 6656
  ds_read_b128 a[4:7], v251 offset:40272
  buffer_load_dwordx4 v253, s[16:19], s34 offen offset:0 lds
  v_mfma_f32_16x16x32_bf16 v[40:43], a[12:15], v[224:227], v[40:43]
  ds_read_b128 a[8:11], v251 offset:40208
  v_mul_f32 v241, v113, v9
  v_mfma_f32_16x16x32_bf16 v[40:43], a[68:71], v[232:235], v[40:43]
  s_waitcnt lgkmcnt(7)
  ds_read_b128 a[12:15], v251 offset:40144
  v_add_u32 v251, 46592, v251
  v_mfma_f32_16x16x32_bf16 v[44:47], a[72:75], v[232:235], v[44:47]
  ds_read_b128 a[16:19], v251 offset:0
  v_mul_f32 v248, v117, v13
  v_mfma_f32_16x16x32_bf16 v[44:47], a[24:27], v[224:227], v[44:47]
  s_add_u32 m0, s33, 8768
  ds_read_b128 a[20:23], v251 offset:64
  buffer_load_dwordx4 v253, s[16:19], s35 offen offset:0 lds
  v_mfma_f32_16x16x32_bf16 v[44:47], a[28:31], v[216:219], v[44:47]
  ds_read_b128 a[24:27], v251 offset:128
  v_mfma_f32_16x16x32_bf16 v[44:47], a[32:35], v[208:211], v[44:47]
  s_waitcnt lgkmcnt(7)
  ds_read_b64 a[60:61], v252 offset:0
  v_cvt_pk_bf16_f32 v241, v241, v248
  v_mfma_f32_16x16x32_bf16 v[48:51], a[36:39], v[208:211], v[48:51]
  ds_read_b64 a[64:65], v252 offset:208
  v_mul_f32 v242, v114, v10
  v_mfma_f32_16x16x32_bf16 v[48:51], a[40:43], v[216:219], v[48:51]
  s_add_u32 m0, s33, 10880
  ds_read_b128 a[36:39], v251 offset:336
  buffer_load_dwordx4 v253, s[16:19], s36 offen offset:0 lds
  v_mfma_f32_16x16x32_bf16 v[48:51], a[44:47], v[224:227], v[48:51]
  ds_read_b128 a[40:43], v251 offset:272
  v_mul_f32 v248, v118, v14
  v_mfma_f32_16x16x32_bf16 v[48:51], a[52:55], v[232:235], v[48:51]
  s_waitcnt lgkmcnt(7)
  ds_read_b128 a[44:47], v251 offset:208
  v_cvt_pk_bf16_f32 v242, v242, v248
  v_mfma_f32_16x16x32_bf16 v[52:55], a[56:59], v[232:235], v[52:55]
  ds_read_b128 a[48:51], v251 offset:6656
  v_mul_f32 v243, v115, v11
  v_mfma_f32_16x16x32_bf16 v[52:55], a[4:7], v[224:227], v[52:55]
  s_add_u32 m0, s33, 19840
  ds_read_b128 a[0:3], v251 offset:6720
  buffer_load_dwordx4 v253, s[16:19], s34 offen offset:128 lds
  v_mfma_f32_16x16x32_bf16 v[52:55], a[8:11], v[216:219], v[52:55]
  ds_read_b128 a[4:7], v251 offset:6784
  v_mfma_f32_16x16x32_bf16 v[52:55], a[12:15], v[208:211], v[52:55]
  s_waitcnt vmcnt(10) lgkmcnt(7)
  ds_read_b64 a[68:69], v252 offset:6656
  v_mul_f32 v248, v119, v15
  v_mfma_f32_16x16x32_bf16 v[56:59], a[16:19], v[208:211], v[56:59]
  s_barrier
  ds_read_b64 a[72:73], v252 offset:6864
  v_cvt_pk_bf16_f32 v243, v243, v248
  v_mfma_f32_16x16x32_bf16 v[56:59], a[20:23], v[216:219], v[56:59]
  s_add_u32 m0, s33, 21952
  ds_read_b128 a[16:19], v251 offset:6992
  buffer_load_dwordx4 v253, s[16:19], s35 offen offset:128 lds
  v_mfma_f32_16x16x32_bf16 v[56:59], a[24:27], v[224:227], v[56:59]
  ds_read_b128 a[20:23], v251 offset:6928
  v_mfma_f32_16x16x32_bf16 v[56:59], a[60:63], v[232:235], v[56:59]
  s_waitcnt lgkmcnt(7)
  ds_read_b128 a[24:27], v251 offset:6864
  v_mul_f32 v244, v120, v16
  v_mfma_f32_16x16x32_bf16 v[60:63], a[64:67], v[232:235], v[60:63]
  ds_read_b128 a[28:31], v251 offset:13312
  v_mfma_f32_16x16x32_bf16 v[60:63], a[36:39], v[224:227], v[60:63]
  s_add_u32 m0, s33, 24064
  ds_read_b128 a[32:35], v251 offset:13376
  buffer_load_dwordx4 v253, s[16:19], s36 offen offset:128 lds
  v_mfma_f32_16x16x32_bf16 v[60:63], a[40:43], v[216:219], v[60:63]
  ds_read_b128 a[36:39], v251 offset:13440
  v_mul_f32 v248, v124, v20
  v_mfma_f32_16x16x32_bf16 v[60:63], a[44:47], v[208:211], v[60:63]
  s_waitcnt lgkmcnt(7)
  ds_read_b64 a[52:53], v252 offset:13312
  v_mfma_f32_16x16x32_bf16 v[64:67], a[48:51], v[208:211], v[64:67]
  ds_read_b64 a[56:57], v252 offset:13520
  v_mfma_f32_16x16x32_bf16 v[64:67], a[0:3], v[216:219], v[64:67]
  s_add_u32 m0, s33, 33024
  ds_read_b128 a[48:51], v251 offset:13648
  buffer_load_dwordx4 v253, s[16:19], s34 offen offset:256 lds
  v_mfma_f32_16x16x32_bf16 v[64:67], a[4:7], v[224:227], v[64:67]
  ds_read_b128 a[0:3], v251 offset:13584
  v_cvt_pk_bf16_f32 v244, v244, v248
  v_mfma_f32_16x16x32_bf16 v[64:67], a[68:71], v[232:235], v[64:67]
  s_waitcnt lgkmcnt(7)
  ds_read_b128 a[4:7], v251 offset:13520
  v_mfma_f32_16x16x32_bf16 v[68:71], a[72:75], v[232:235], v[68:71]
  ds_read_b128 a[8:11], v251 offset:19968
  v_mul_f32 v245, v121, v17
  v_mfma_f32_16x16x32_bf16 v[68:71], a[16:19], v[224:227], v[68:71]
  s_add_u32 m0, s33, 35136
  ds_read_b128 a[12:15], v251 offset:20032
  buffer_load_dwordx4 v253, s[16:19], s35 offen offset:256 lds
  v_mfma_f32_16x16x32_bf16 v[68:71], a[20:23], v[216:219], v[68:71]
  ds_read_b128 a[16:19], v251 offset:20096
  v_mfma_f32_16x16x32_bf16 v[68:71], a[24:27], v[208:211], v[68:71]
  s_waitcnt vmcnt(11) lgkmcnt(7)
  ds_read_b64 a[60:61], v252 offset:19968
  v_mfma_f32_16x16x32_bf16 v[72:75], a[28:31], v[208:211], v[72:75]
  s_barrier
  ds_read_b64 a[64:65], v252 offset:20176
  v_mul_f32 v248, v125, v21
  v_mfma_f32_16x16x32_bf16 v[72:75], a[32:35], v[216:219], v[72:75]
  s_add_u32 m0, s33, 37248
  ds_read_b128 a[28:31], v251 offset:20304
  buffer_load_dwordx4 v253, s[16:19], s36 offen offset:256 lds
  v_mfma_f32_16x16x32_bf16 v[72:75], a[36:39], v[224:227], v[72:75]
  ds_read_b128 a[32:35], v251 offset:20240
  v_mfma_f32_16x16x32_bf16 v[72:75], a[52:55], v[232:235], v[72:75]
  s_waitcnt lgkmcnt(7)
  ds_read_b128 a[36:39], v251 offset:20176
  v_cvt_pk_bf16_f32 v245, v245, v248
  v_mfma_f32_16x16x32_bf16 v[76:79], a[56:59], v[232:235], v[76:79]
  ds_read_b128 a[40:43], v251 offset:26624
  v_mfma_f32_16x16x32_bf16 v[76:79], a[48:51], v[224:227], v[76:79]
  s_add_u32 m0, s33, 46208
  ds_read_b128 a[44:47], v251 offset:26688
  buffer_load_dwordx4 v253, s[16:19], s34 offen offset:384 lds
  v_mfma_f32_16x16x32_bf16 v[76:79], a[0:3], v[216:219], v[76:79]
  ds_read_b128 a[48:51], v251 offset:26752
  v_mfma_f32_16x16x32_bf16 v[76:79], a[4:7], v[208:211], v[76:79]
  s_waitcnt lgkmcnt(7)
  ds_read_b64 a[68:69], v252 offset:26624
  v_mul_f32 v246, v122, v18
  v_mfma_f32_16x16x32_bf16 v[80:83], a[8:11], v[208:211], v[80:83]
  ds_read_b64 a[72:73], v252 offset:26832
  v_mfma_f32_16x16x32_bf16 v[80:83], a[12:15], v[216:219], v[80:83]
  s_add_u32 m0, s33, 48320
  ds_read_b128 a[8:11], v251 offset:26960
  buffer_load_dwordx4 v253, s[16:19], s35 offen offset:384 lds
  v_mfma_f32_16x16x32_bf16 v[80:83], a[16:19], v[224:227], v[80:83]
  ds_read_b128 a[12:15], v251 offset:26896
  v_mul_f32 v248, v126, v22
  v_mfma_f32_16x16x32_bf16 v[80:83], a[60:63], v[232:235], v[80:83]
  s_waitcnt lgkmcnt(7)
  ds_read_b128 a[16:19], v251 offset:26832
  v_mfma_f32_16x16x32_bf16 v[84:87], a[64:67], v[232:235], v[84:87]
  ds_read_b128 a[20:23], v251 offset:33280
  v_mfma_f32_16x16x32_bf16 v[84:87], a[28:31], v[224:227], v[84:87]
  s_add_u32 m0, s33, 50432
  ds_read_b128 a[24:27], v251 offset:33344
  buffer_load_dwordx4 v253, s[16:19], s36 offen offset:384 lds
  v_mfma_f32_16x16x32_bf16 v[84:87], a[32:35], v[216:219], v[84:87]
  ds_read_b128 a[28:31], v251 offset:33408
  v_cvt_pk_bf16_f32 v246, v246, v248
  v_mfma_f32_16x16x32_bf16 v[84:87], a[36:39], v[208:211], v[84:87]
  s_waitcnt vmcnt(9) lgkmcnt(7)
  ds_read_b64 a[52:53], v252 offset:33280
  v_mfma_f32_16x16x32_bf16 v[88:91], a[40:43], v[208:211], v[88:91]
  s_barrier
  ds_read_b64 a[56:57], v252 offset:33488
  v_mul_f32 v247, v123, v19
  v_mfma_f32_16x16x32_bf16 v[88:91], a[44:47], v[216:219], v[88:91]
  s_add_u32 m0, s33, 59392
  ds_read_b128 a[40:43], v251 offset:33616
  buffer_load_dwordx4 v253, s[16:19], s34 offen offset:512 lds
  v_mfma_f32_16x16x32_bf16 v[88:91], a[48:51], v[224:227], v[88:91]
  ds_read_b128 a[44:47], v251 offset:33552
  v_mfma_f32_16x16x32_bf16 v[88:91], a[68:71], v[232:235], v[88:91]
  s_waitcnt lgkmcnt(7)
  ds_read_b128 a[48:51], v251 offset:33488
  v_subrev_u32 v251, 46592, v251
  v_mfma_f32_16x16x32_bf16 v[92:95], a[72:75], v[232:235], v[92:95]
  ds_read_b128 a[0:3], v249 offset:44544
  v_mfma_f32_16x16x32_bf16 v[92:95], a[8:11], v[224:227], v[92:95]
  s_add_u32 m0, s33, 61504
  ds_read_b128 a[4:7], v249 offset:51200
  buffer_load_dwordx4 v253, s[16:19], s35 offen offset:512 lds
  v_mfma_f32_16x16x32_bf16 v[92:95], a[12:15], v[216:219], v[92:95]
  ds_read_b128 a[8:11], v249 offset:57856
  v_subrev_u32 v249, 46592, v249
  v_mfma_f32_16x16x32_bf16 v[92:95], a[16:19], v[208:211], v[92:95]
  s_waitcnt lgkmcnt(7)
  ds_read_b128 a[12:15], v249 offset:6656
  v_mul_f32 v248, v127, v23
  v_mfma_f32_16x16x32_bf16 v[96:99], a[20:23], v[208:211], v[96:99]
  ds_read_b128 a[16:19], v249 offset:8768
  v_mfma_f32_16x16x32_bf16 v[96:99], a[24:27], v[216:219], v[96:99]
  s_add_u32 m0, s33, 63616
  ds_read_b128 a[20:23], v249 offset:10880
  buffer_load_dwordx4 v253, s[16:19], s36 offen offset:512 lds
  v_mfma_f32_16x16x32_bf16 v[96:99], a[28:31], v[224:227], v[96:99]
  ds_read_b128 a[24:27], v250 offset:0
  v_cvt_pk_bf16_f32 v247, v247, v248
  v_mfma_f32_16x16x32_bf16 v[96:99], a[52:55], v[232:235], v[96:99]
  s_waitcnt lgkmcnt(7)
  ds_read_b128 a[28:31], v250 offset:64
  v_mfma_f32_16x16x32_bf16 v[100:103], a[56:59], v[232:235], v[100:103]
  ds_read_b128 a[32:35], v249 offset:17536
  v_mfma_f32_16x16x32_bf16 v[100:103], a[40:43], v[224:227], v[100:103]
  ds_read_b128 a[36:39], v249 offset:10944
  v_mfma_f32_16x16x32_bf16 v[100:103], a[44:47], v[216:219], v[100:103]
  ds_read_b128 a[40:43], v249 offset:15424
  v_mfma_f32_16x16x32_bf16 v[100:103], a[48:51], v[208:211], v[100:103]
  s_waitcnt lgkmcnt(9)
  ds_read_b128 a[44:47], v249 offset:8832
  v_mfma_f32_16x16x32_bf16 v[212:215], a[0:3], v[236:239], 0
  ds_read_b128 a[48:51], v249 offset:13312
  v_accvgpr_read_b32 v248, a77
  v_mfma_f32_16x16x32_bf16 v[220:223], a[4:7], v[236:239], 0
  s_waitcnt vmcnt(6) lgkmcnt(7)
  ds_read_b128 a[0:3], v249 offset:6720
  v_add_u32 v252, v252, v248
  v_mfma_f32_16x16x32_bf16 v[228:231], a[8:11], v[236:239], 0
  s_barrier
  ds_read_b128 a[4:7], v249 offset:19968
  v_add_u32 v254, 86528, v254
  v_mfma_f32_16x16x32_bf16 v[208:211], a[12:15], v[236:239], 0
  s_add_u32 m0, s33, 72576
  ds_read_b128 a[8:11], v249 offset:13376
  buffer_load_dwordx4 v253, s[16:19], s34 offen offset:640 lds
  v_mfma_f32_16x16x32_bf16 v[216:219], a[16:19], v[236:239], 0
  ds_read_b128 a[12:15], v249 offset:22080
  v_mfma_f32_16x16x32_bf16 v[224:227], a[20:23], v[236:239], 0
  s_waitcnt lgkmcnt(7)
  ds_read_b128 a[16:19], v249 offset:15488
  v_mfma_f32_16x16x32_bf16 v[232:235], a[24:27], v[236:239], 0
  ds_read_b128 a[20:23], v249 offset:24192
  v_mfma_f32_16x16x32_bf16 v[232:235], a[28:31], v[240:243], v[232:235]
  s_add_u32 m0, s33, 74688
  ds_read_b128 a[24:27], v249 offset:17600
  buffer_load_dwordx4 v253, s[16:19], s35 offen offset:640 lds
  v_mul_f32 v236, v128, v24
  v_mfma_f32_16x16x32_bf16 v[228:231], a[32:35], v[240:243], v[228:231]
  ds_read_b128 a[28:31], v250 offset:128
  v_mul_f32 v248, v132, v28
  v_cvt_pk_bf16_f32 v236, v236, v248
  v_mfma_f32_16x16x32_bf16 v[224:227], a[36:39], v[240:243], v[224:227]
  s_waitcnt lgkmcnt(7)
  ds_read_b128 a[32:35], v250 offset:192
  v_mul_f32 v237, v129, v25
  v_mfma_f32_16x16x32_bf16 v[220:223], a[40:43], v[240:243], v[220:223]
  ds_read_b128 a[36:39], v249 offset:30848
  v_mul_f32 v248, v133, v29
  v_cvt_pk_bf16_f32 v237, v237, v248
  v_mfma_f32_16x16x32_bf16 v[216:219], a[44:47], v[240:243], v[216:219]
  s_add_u32 m0, s33, 76800
  ds_read_b128 a[40:43], v249 offset:24256
  buffer_load_dwordx4 v253, s[16:19], s36 offen offset:640 lds
  v_mul_f32 v238, v130, v26
  v_mfma_f32_16x16x32_bf16 v[212:215], a[48:51], v[240:243], v[212:215]
  ds_read_b128 a[44:47], v249 offset:28736
  v_mul_f32 v248, v134, v30
  v_cvt_pk_bf16_f32 v238, v238, v248
  v_mfma_f32_16x16x32_bf16 v[208:211], a[0:3], v[240:243], v[208:211]
  s_waitcnt lgkmcnt(7)
  ds_read_b128 a[48:51], v249 offset:22144
  v_mul_f32 v239, v131, v27
  v_mfma_f32_16x16x32_bf16 v[208:211], a[4:7], v[244:247], v[208:211]
  ds_read_b128 a[0:3], v249 offset:26624
  v_mul_f32 v248, v135, v31
  v_cvt_pk_bf16_f32 v239, v239, v248
  v_mfma_f32_16x16x32_bf16 v[212:215], a[8:11], v[244:247], v[212:215]
  ds_read_b128 a[4:7], v249 offset:20032
  v_mul_f32 v240, v136, v32
  v_mul_f32 v248, v140, v36
  v_mfma_f32_16x16x32_bf16 v[216:219], a[12:15], v[244:247], v[216:219]
  ds_read_b128 a[8:11], v249 offset:33280
  v_cvt_pk_bf16_f32 v240, v240, v248
  v_mul_f32 v241, v137, v33
  v_mfma_f32_16x16x32_bf16 v[220:223], a[16:19], v[244:247], v[220:223]
  s_waitcnt lgkmcnt(9)
  ds_read_b128 a[12:15], v249 offset:26688
  v_mul_f32 v248, v141, v37
  v_cvt_pk_bf16_f32 v241, v241, v248
  v_mfma_f32_16x16x32_bf16 v[224:227], a[20:23], v[244:247], v[224:227]
  ds_read_b128 a[16:19], v249 offset:35392
  v_mul_f32 v242, v138, v34
  v_mfma_f32_16x16x32_bf16 v[228:231], a[24:27], v[244:247], v[228:231]
  s_waitcnt vmcnt(6) lgkmcnt(7)
  ds_read_b128 a[20:23], v249 offset:28800
  v_mul_f32 v248, v142, v38
  v_cvt_pk_bf16_f32 v242, v242, v248
  v_mfma_f32_16x16x32_bf16 v[232:235], a[28:31], v[244:247], v[232:235]
  s_barrier
  ds_read_b128 a[24:27], v249 offset:37504
  v_mul_f32 v243, v139, v35
  v_mul_f32 v248, v143, v39
  v_mfma_f32_16x16x32_bf16 v[232:235], a[32:35], v[236:239], v[232:235]
  s_add_u32 m0, s45, 0
  ds_read_b128 a[28:31], v249 offset:30912
  buffer_load_dwordx4 v254, s[12:15], m0 offen offset:0 lds
  v_cvt_pk_bf16_f32 v243, v243, v248
  v_mfma_f32_16x16x32_bf16 v[228:231], a[36:39], v[236:239], v[228:231]
  ds_read_b128 a[32:35], v250 offset:256
  v_mul_f32 v244, v144, v40
  v_mul_f32 v248, v148, v44
  v_mfma_f32_16x16x32_bf16 v[224:227], a[40:43], v[236:239], v[224:227]
  s_waitcnt lgkmcnt(7)
  ds_read_b128 a[36:39], v250 offset:320
  v_cvt_pk_bf16_f32 v244, v244, v248
  v_mul_f32 v245, v145, v41
  v_mfma_f32_16x16x32_bf16 v[220:223], a[44:47], v[236:239], v[220:223]
  ds_read_b128 a[40:43], v249 offset:44160
  v_mul_f32 v248, v149, v45
  v_mfma_f32_16x16x32_bf16 v[216:219], a[48:51], v[236:239], v[216:219]
  ds_read_b128 a[44:47], v249 offset:37568
  buffer_load_dwordx4 v254, s[12:15], m0 offen offset:1024 lds
  v_cvt_pk_bf16_f32 v245, v245, v248
  v_mfma_f32_16x16x32_bf16 v[212:215], a[0:3], v[236:239], v[212:215]
  ds_read_b128 a[48:51], v249 offset:42048
  v_mul_f32 v246, v146, v42
  v_mul_f32 v248, v150, v46
  v_mfma_f32_16x16x32_bf16 v[208:211], a[4:7], v[236:239], v[208:211]
  s_waitcnt lgkmcnt(7)
  ds_read_b128 a[0:3], v249 offset:35456
  v_cvt_pk_bf16_f32 v246, v246, v248
  v_mul_f32 v247, v147, v43
  v_mfma_f32_16x16x32_bf16 v[208:211], a[8:11], v[240:243], v[208:211]
  ds_read_b128 a[4:7], v249 offset:39936
  v_mul_f32 v248, v151, v47
  v_mfma_f32_16x16x32_bf16 v[212:215], a[12:15], v[240:243], v[212:215]
  ds_read_b128 a[8:11], v249 offset:33344
  buffer_load_dwordx4 v254, s[12:15], m0 offen offset:2048 lds
  v_cvt_pk_bf16_f32 v247, v247, v248
  v_mfma_f32_16x16x32_bf16 v[216:219], a[16:19], v[240:243], v[216:219]
  ds_read_b128 a[12:15], v249 offset:46592
  v_mul_f32 v236, v152, v48
  v_mul_f32 v248, v156, v52
  v_mfma_f32_16x16x32_bf16 v[220:223], a[20:23], v[240:243], v[220:223]
  s_waitcnt lgkmcnt(9)
  ds_read_b128 a[16:19], v249 offset:40000
  v_cvt_pk_bf16_f32 v236, v236, v248
  v_mul_f32 v237, v153, v49
  v_mfma_f32_16x16x32_bf16 v[224:227], a[24:27], v[240:243], v[224:227]
  ds_read_b128 a[20:23], v249 offset:48704
  v_mul_f32 v248, v157, v53
  v_cvt_pk_bf16_f32 v237, v237, v248
  v_mfma_f32_16x16x32_bf16 v[228:231], a[28:31], v[240:243], v[228:231]
  s_waitcnt vmcnt(6) lgkmcnt(8)
  ds_read_b128 a[24:27], v249 offset:42112
  buffer_load_dwordx4 v254, s[12:15], m0 offen offset:3072 lds
  v_mfma_f32_16x16x32_bf16 v[232:235], a[32:35], v[240:243], v[232:235]
  s_barrier
  ds_read_b128 a[28:31], v249 offset:50816
  v_mul_f32 v238, v154, v50
  v_mul_f32 v248, v158, v54
  v_mfma_f32_16x16x32_bf16 v[232:235], a[36:39], v[244:247], v[232:235]
  ds_read_b128 a[32:35], v249 offset:44224
  v_cvt_pk_bf16_f32 v238, v238, v248
  v_mul_f32 v239, v155, v51
  v_mfma_f32_16x16x32_bf16 v[228:231], a[40:43], v[244:247], v[228:231]
  s_waitcnt lgkmcnt(7)
  ds_read_b128 a[36:39], v250 offset:384
  v_mul_f32 v248, v159, v55
  v_cvt_pk_bf16_f32 v239, v239, v248
  v_mfma_f32_16x16x32_bf16 v[224:227], a[44:47], v[244:247], v[224:227]
  s_add_u32 m0, s45, 16384
  ds_read_b128 a[40:43], v250 offset:448
  buffer_load_dwordx4 v254, s[12:15], m0 offen offset:0 lds
  v_mul_f32 v240, v160, v56
  v_mfma_f32_16x16x32_bf16 v[220:223], a[48:51], v[244:247], v[220:223]
  ds_read_b128 a[44:47], v249 offset:57472
  v_mul_f32 v248, v164, v60
  v_cvt_pk_bf16_f32 v240, v240, v248
  v_mfma_f32_16x16x32_bf16 v[216:219], a[0:3], v[244:247], v[216:219]
  ds_read_b128 a[48:51], v249 offset:50880
  v_mul_f32 v241, v161, v57
  v_mul_f32 v248, v165, v61
  v_mfma_f32_16x16x32_bf16 v[212:215], a[4:7], v[244:247], v[212:215]
  s_waitcnt lgkmcnt(7)
  ds_read_b128 a[0:3], v249 offset:55360
  v_cvt_pk_bf16_f32 v241, v241, v248
  v_mul_f32 v242, v162, v58
  v_mfma_f32_16x16x32_bf16 v[208:211], a[8:11], v[244:247], v[208:211]
  ds_read_b128 a[4:7], v249 offset:48768
  buffer_load_dwordx4 v254, s[12:15], m0 offen offset:1024 lds
  v_mfma_f32_16x16x32_bf16 v[208:211], a[12:15], v[236:239], v[208:211]
  ds_read_b128 a[8:11], v249 offset:53248
  v_mul_f32 v248, v166, v62
  v_cvt_pk_bf16_f32 v242, v242, v248
  v_mfma_f32_16x16x32_bf16 v[212:215], a[16:19], v[236:239], v[212:215]
  ds_read_b128 a[12:15], v249 offset:46656
  v_add_u32 v249, 46592, v249
  v_mul_f32 v243, v163, v59
  v_mfma_f32_16x16x32_bf16 v[216:219], a[20:23], v[236:239], v[216:219]
  s_waitcnt lgkmcnt(7)
  ds_read_b128 a[16:19], v249 offset:13312
  v_mul_f32 v248, v167, v63
  v_cvt_pk_bf16_f32 v243, v243, v248
  v_mfma_f32_16x16x32_bf16 v[220:223], a[24:27], v[236:239], v[220:223]
  ds_read_b128 a[20:23], v249 offset:6720
  buffer_load_dwordx4 v254, s[12:15], m0 offen offset:2048 lds
  v_mul_f32 v244, v168, v64
  v_mfma_f32_16x16x32_bf16 v[224:227], a[28:31], v[236:239], v[224:227]
  ds_read_b128 a[24:27], v249 offset:15424
  v_mul_f32 v248, v172, v68
  v_cvt_pk_bf16_f32 v244, v244, v248
  v_mfma_f32_16x16x32_bf16 v[228:231], a[32:35], v[236:239], v[228:231]
  ds_read_b128 a[28:31], v249 offset:8832
  v_mul_f32 v245, v169, v65
  v_mfma_f32_16x16x32_bf16 v[232:235], a[36:39], v[236:239], v[232:235]
  s_waitcnt lgkmcnt(7)
  ds_read_b128 a[32:35], v249 offset:17536
  v_mul_f32 v248, v173, v69
  v_cvt_pk_bf16_f32 v245, v245, v248
  v_mfma_f32_16x16x32_bf16 v[232:235], a[40:43], v[240:243], v[232:235]
  ds_read_b128 a[36:39], v249 offset:10944
  buffer_load_dwordx4 v254, s[12:15], m0 offen offset:3072 lds
  v_mul_f32 v246, v170, v66
  v_mfma_f32_16x16x32_bf16 v[228:231], a[44:47], v[240:243], v[228:231]
  ds_read_b128 a[40:43], v250 offset:512
  v_mul_f32 v248, v174, v70
  v_cvt_pk_bf16_f32 v246, v246, v248
  v_mfma_f32_16x16x32_bf16 v[224:227], a[48:51], v[240:243], v[224:227]
  ds_read_b128 a[44:47], v250 offset:576
  v_mul_f32 v247, v171, v67
  v_mfma_f32_16x16x32_bf16 v[220:223], a[0:3], v[240:243], v[220:223]
  s_waitcnt lgkmcnt(10)
  ds_read_b128 a[48:51], v249 offset:24192
  v_mul_f32 v248, v175, v71
  v_cvt_pk_bf16_f32 v247, v247, v248
  v_mfma_f32_16x16x32_bf16 v[216:219], a[4:7], v[240:243], v[216:219]
  s_waitcnt vmcnt(8) lgkmcnt(7)
  ds_read_b128 a[0:3], v249 offset:17600
  v_mul_f32 v236, v176, v72
  v_mul_f32 v248, v180, v76
  v_mfma_f32_16x16x32_bf16 v[212:215], a[8:11], v[240:243], v[212:215]
  s_barrier
  ds_read_b128 a[4:7], v249 offset:22080
  v_cvt_pk_bf16_f32 v236, v236, v248
  v_mul_f32 v237, v177, v73
  v_mfma_f32_16x16x32_bf16 v[208:211], a[12:15], v[240:243], v[208:211]
  s_add_u32 m0, s45, 32768
  ds_read_b128 a[8:11], v249 offset:15488
  buffer_load_dwordx4 v254, s[12:15], m0 offen offset:0 lds
  v_mul_f32 v248, v181, v77
  v_mfma_f32_16x16x32_bf16 v[208:211], a[16:19], v[244:247], v[208:211]
  ds_read_b128 a[12:15], v249 offset:19968
  v_cvt_pk_bf16_f32 v237, v237, v248
  v_mul_f32 v238, v178, v74
  v_mfma_f32_16x16x32_bf16 v[212:215], a[20:23], v[244:247], v[212:215]
  s_waitcnt lgkmcnt(7)
  ds_read_b128 a[16:19], v249 offset:13376
  v_mul_f32 v248, v182, v78
  v_cvt_pk_bf16_f32 v238, v238, v248
  v_mfma_f32_16x16x32_bf16 v[216:219], a[24:27], v[244:247], v[216:219]
  ds_read_b128 a[20:23], v249 offset:26624
  v_mul_f32 v239, v179, v75
  v_mul_f32 v248, v183, v79
  v_mfma_f32_16x16x32_bf16 v[220:223], a[28:31], v[244:247], v[220:223]
L_tA0:
  s_cbranch_execz L_tret
  ds_read_b128 a[24:27], v249 offset:20032
  buffer_load_dwordx4 v254, s[12:15], m0 offen offset:1024 lds
  v_cvt_pk_bf16_f32 v239, v239, v248
  v_mfma_f32_16x16x32_bf16 v[224:227], a[32:35], v[244:247], v[224:227]
  ds_read_b128 a[28:31], v249 offset:28736
  v_mul_f32 v240, v184, v80
  v_mul_f32 v248, v188, v84
  v_mfma_f32_16x16x32_bf16 v[228:231], a[36:39], v[244:247], v[228:231]
  s_waitcnt lgkmcnt(7)
  ds_read_b128 a[32:35], v249 offset:22144
  v_cvt_pk_bf16_f32 v240, v240, v248
  v_mul_f32 v241, v185, v81
  v_mfma_f32_16x16x32_bf16 v[232:235], a[40:43], v[244:247], v[232:235]
  ds_read_b128 a[36:39], v249 offset:30848
  v_mul_f32 v248, v189, v85
  v_mfma_f32_16x16x32_bf16 v[232:235], a[44:47], v[236:239], v[232:235]
  ds_read_b128 a[40:43], v249 offset:24256
  buffer_load_dwordx4 v254, s[12:15], m0 offen offset:2048 lds
  v_cvt_pk_bf16_f32 v241, v241, v248
  v_mfma_f32_16x16x32_bf16 v[228:231], a[48:51], v[236:239], v[228:231]
  ds_read_b128 a[44:47], v250 offset:640
  v_mul_f32 v242, v186, v82
  v_mul_f32 v248, v190, v86
  v_mfma_f32_16x16x32_bf16 v[224:227], a[0:3], v[236:239], v[224:227]
  s_waitcnt lgkmcnt(9)
  ds_read_b128 a[48:51], v250 offset:704
  v_cvt_pk_bf16_f32 v242, v242, v248
  v_mul_f32 v243, v187, v83
  v_mfma_f32_16x16x32_bf16 v[220:223], a[4:7], v[236:239], v[220:223]
  ds_read_b128 a[0:3], v249 offset:37504
  v_mul_f32 v248, v191, v87
  v_mfma_f32_16x16x32_bf16 v[216:219], a[8:11], v[236:239], v[216:219]
  s_waitcnt vmcnt(7) lgkmcnt(8)
  ds_read_b128 a[4:7], v249 offset:30912
  buffer_load_dwordx4 v254, s[12:15], m0 offen offset:3072 lds
  v_cvt_pk_bf16_f32 v243, v243, v248
  v_mfma_f32_16x16x32_bf16 v[212:215], a[12:15], v[236:239], v[212:215]
  s_barrier
  ds_read_b128 a[8:11], v249 offset:35392
  buffer_load_dword a87, v254, s[12:15], s5 offen
  v_mul_f32 v244, v192, v88
  v_mfma_f32_16x16x32_bf16 v[208:211], a[16:19], v[236:239], v[208:211]
  ds_read_b128 a[12:15], v249 offset:28800
  v_mul_f32 v248, v196, v92
  v_cvt_pk_bf16_f32 v244, v244, v248
  v_mfma_f32_16x16x32_bf16 v[208:211], a[20:23], v[240:243], v[208:211]
  s_waitcnt lgkmcnt(7)
  ds_read_b128 a[16:19], v249 offset:33280
  v_mul_f32 v245, v193, v89
  v_mul_f32 v248, v197, v93
  v_mfma_f32_16x16x32_bf16 v[212:215], a[24:27], v[240:243], v[212:215]
  s_add_u32 m0, s45, 49152
  ds_read_b128 a[20:23], v249 offset:26688
  buffer_load_dwordx4 v254, s[12:15], m0 offen offset:0 lds
  v_cvt_pk_bf16_f32 v245, v245, v248
  v_mfma_f32_16x16x32_bf16 v[216:219], a[28:31], v[240:243], v[216:219]
  ds_read_b128 a[24:27], v249 offset:44480
  v_mul_f32 v246, v194, v90
  v_mul_f32 v248, v198, v94
  v_mfma_f32_16x16x32_bf16 v[220:223], a[32:35], v[240:243], v[220:223]
  ds_read_b128 a[28:31], v249 offset:33344
  v_cvt_pk_bf16_f32 v246, v246, v248
  v_mul_f32 v247, v195, v91
  v_mfma_f32_16x16x32_bf16 v[224:227], a[36:39], v[240:243], v[224:227]
  s_waitcnt lgkmcnt(7)
  ds_read_b128 a[32:35], v249 offset:51136
  v_mul_f32 v248, v199, v95
  v_cvt_pk_bf16_f32 v247, v247, v248
  v_mfma_f32_16x16x32_bf16 v[228:231], a[40:43], v[240:243], v[228:231]
  ds_read_b128 a[36:39], v249 offset:35456
  buffer_load_dwordx4 v254, s[12:15], m0 offen offset:1024 lds
  v_mul_f32 v236, v200, v96
  v_mfma_f32_16x16x32_bf16 v[232:235], a[44:47], v[240:243], v[232:235]
  ds_read_b128 a[40:43], v249 offset:57792
  v_mul_f32 v248, v204, v100
  v_cvt_pk_bf16_f32 v236, v236, v248
  v_mfma_f32_16x16x32_bf16 v[232:235], a[48:51], v[244:247], v[232:235]
  ds_read_b128 a[44:47], v249 offset:37568
  v_mul_f32 v237, v201, v97
  v_mfma_f32_16x16x32_bf16 v[228:231], a[0:3], v[244:247], v[228:231]
  s_waitcnt lgkmcnt(7)
  ds_read_b128 a[48:51], v250 offset:768
  v_mul_f32 v248, v205, v101
  v_cvt_pk_bf16_f32 v237, v237, v248
  v_mfma_f32_16x16x32_bf16 v[224:227], a[4:7], v[244:247], v[224:227]
  ds_read_b128 a[0:3], v251 offset:0
  buffer_load_dwordx4 v254, s[12:15], m0 offen offset:2048 lds
  v_mul_f32 v238, v202, v98
  v_mfma_f32_16x16x32_bf16 v[220:223], a[8:11], v[244:247], v[220:223]
  ds_read_b128 a[4:7], v251 offset:208
  v_mul_f32 v248, v206, v102
  v_cvt_pk_bf16_f32 v238, v238, v248
  v_mfma_f32_16x16x32_bf16 v[216:219], a[12:15], v[244:247], v[216:219]
  ds_read_b128 a[8:11], v251 offset:6656
  v_mul_f32 v239, v203, v99
  v_mfma_f32_16x16x32_bf16 v[212:215], a[16:19], v[244:247], v[212:215]
  s_waitcnt lgkmcnt(7)
  ds_read_b128 a[12:15], v251 offset:6864
  v_mul_f32 v248, v207, v103
  v_cvt_pk_bf16_f32 v239, v239, v248
  v_mfma_f32_16x16x32_bf16 v[208:211], a[20:23], v[244:247], v[208:211]
  ds_read_b128 a[16:19], v251 offset:64
  buffer_load_dwordx4 v254, s[12:15], m0 offen offset:3072 lds
  v_mfma_f32_16x16x32_bf16 v[208:211], a[24:27], v[236:239], v[208:211]
  ds_read_b128 a[20:23], v251 offset:272
  v_mfma_f32_16x16x32_bf16 v[212:215], a[28:31], v[236:239], v[212:215]
  ds_read_b128 a[24:27], v251 offset:6720
  v_mfma_f32_16x16x32_bf16 v[216:219], a[32:35], v[236:239], v[216:219]
  s_waitcnt lgkmcnt(7)
  ds_read_b128 a[28:31], v251 offset:6928
  v_add_u32 v253, 86528, v253
  v_mfma_f32_16x16x32_bf16 v[220:223], a[36:39], v[236:239], v[220:223]
  ds_read_b128 a[32:35], v251 offset:128
  v_mfma_f32_16x16x32_bf16 v[224:227], a[40:43], v[236:239], v[224:227]
  ds_read_b128 a[36:39], v251 offset:336
  v_cvt_pk_bf16_f32 v208, v208, v212
  v_cvt_pk_bf16_f32 v209, v209, v213
  v_mfma_f32_16x16x32_bf16 v[228:231], a[44:47], v[236:239], v[228:231]
  ds_read_b128 a[40:43], v251 offset:6784
  v_cvt_pk_bf16_f32 v210, v210, v214
  v_cvt_pk_bf16_f32 v211, v211, v215
  v_mfma_f32_16x16x32_bf16 v[232:235], a[48:51], v[236:239], v[232:235]
  s_waitcnt vmcnt(9) lgkmcnt(7)
  s_sub_u32 s47, s47, 1
  ds_read_b128 a[44:47], v251 offset:6992
  s_cbranch_scc0 L_loop0
  s_branch L_g2l
.p2align 12
L_tB:
  s_branch L_tB0
L_loop1:
  v_mfma_f32_16x16x32_bf16 v[0:3], a[0:3], v[208:211], v[0:3]
  s_barrier
  ds_read_b64 a[52:53], v252 offset:0
  v_cvt_pk_bf16_f32 v216, v216, v220
  v_mfma_f32_16x16x32_bf16 v[4:7], a[4:7], v[208:211], v[4:7]
  ds_read_b64 a[56:57], v252 offset:208
  v_cvt_pk_bf16_f32 v217, v217, v221
  v_cvt_pk_bf16_f32 v218, v218, v222
  v_mfma_f32_16x16x32_bf16 v[8:11], a[8:11], v[208:211], v[8:11]
  s_waitcnt lgkmcnt(7)
  ds_read_b64 a[60:61], v252 offset:6656
  v_cvt_pk_bf16_f32 v219, v219, v223
  v_mfma_f32_16x16x32_bf16 v[12:15], a[12:15], v[208:211], v[12:15]
  s_add_u32 m0, s45, 65536
  ds_read_b64 a[64:65], v252 offset:6864
  buffer_load_dwordx4 v254, s[12:15], m0 offen offset:0 lds
  v_mfma_f32_16x16x32_bf16 v[0:3], a[16:19], v[216:219], v[0:3]
  ds_read_b128 a[12:15], v251 offset:13312
  v_cvt_pk_bf16_f32 v224, v224, v228
  v_cvt_pk_bf16_f32 v225, v225, v229
  v_mfma_f32_16x16x32_bf16 v[4:7], a[20:23], v[216:219], v[4:7]
  ds_read_b128 a[16:19], v251 offset:13376
  v_cvt_pk_bf16_f32 v226, v226, v230
  v_mfma_f32_16x16x32_bf16 v[8:11], a[24:27], v[216:219], v[8:11]
  s_waitcnt lgkmcnt(7)
  ds_read_b128 a[20:23], v251 offset:13440
  v_cvt_pk_bf16_f32 v227, v227, v231
  v_mfma_f32_16x16x32_bf16 v[12:15], a[28:31], v[216:219], v[12:15]
  ds_read_b64 a[68:69], v252 offset:13312
  buffer_load_dwordx4 v254, s[12:15], m0 offen offset:1024 lds
  v_cvt_pk_bf16_f32 v232, v232, v233
  v_mfma_f32_16x16x32_bf16 v[0:3], a[32:35], v[224:227], v[0:3]
  ds_read_b64 a[72:73], v252 offset:13520
  v_cvt_pk_bf16_f32 v233, v234, v235
  v_mfma_f32_16x16x32_bf16 v[4:7], a[36:39], v[224:227], v[4:7]
  ds_read_b128 a[32:35], v251 offset:13648
  v_mov_b32 v234, 0
  v_mov_b32 v235, 0
  v_mfma_f32_16x16x32_bf16 v[8:11], a[40:43], v[224:227], v[8:11]
  s_waitcnt lgkmcnt(7)
  ds_read_b128 a[36:39], v251 offset:13584
  v_cndmask_b32_e64 v232, v232, 0.5, s[54:55]
  v_mfma_f32_16x16x32_bf16 v[12:15], a[44:47], v[224:227], v[12:15]
  ds_read_b128 a[40:43], v251 offset:13520
  buffer_load_dwordx4 v254, s[12:15], m0 offen offset:2048 lds
  v_mfma_f32_16x16x32_bf16 v[0:3], a[52:55], v[232:235], v[0:3]
  ds_read_b128 a[44:47], v251 offset:19968
  v_mfma_f32_16x16x32_bf16 v[4:7], a[56:59], v[232:235], v[4:7]
  ds_read_b128 a[48:51], v251 offset:20032
  v_mfma_f32_16x16x32_bf16 v[8:11], a[60:63], v[232:235], v[8:11]
  s_waitcnt lgkmcnt(8)
  ds_read_b128 a[0:3], v251 offset:20096
  buffer_load_dword a86, v254, s[16:19], s6 offen
  v_mfma_f32_16x16x32_bf16 v[12:15], a[64:67], v[232:235], v[12:15]
  ds_read_b64 a[52:53], v252 offset:19968
  buffer_load_dwordx4 v254, s[12:15], m0 offen offset:3072 lds
  v_mfma_f32_16x16x32_bf16 v[16:19], a[12:15], v[208:211], v[16:19]
  ds_read_b64 a[56:57], v252 offset:20176
  v_mfma_f32_16x16x32_bf16 v[16:19], a[16:19], v[216:219], v[16:19]
  s_waitcnt lgkmcnt(9)
  ds_read_b128 a[12:15], v251 offset:20304
  v_mfma_f32_16x16x32_bf16 v[16:19], a[20:23], v[224:227], v[16:19]
  s_mov_b32 m0, s46
  ds_read_b128 a[16:19], v251 offset:20240
  v_mul_f32 v236, v104, v0
  v_mfma_f32_16x16x32_bf16 v[16:19], a[68:71], v[232:235], v[16:19]
  s_waitcnt vmcnt(9) lgkmcnt(7)
  ds_read_b128 a[20:23], v251 offset:20176
  buffer_load_dwordx4 v254, s[12:15], m0 offen lds
  v_mfma_f32_16x16x32_bf16 v[20:23], a[72:75], v[232:235], v[20:23]
  s_barrier
  ds_read_b128 a[24:27], v251 offset:26624
  v_mul_f32 v248, v108, v4
  v_mfma_f32_16x16x32_bf16 v[20:23], a[32:35], v[224:227], v[20:23]
  ds_read_b128 a[28:31], v251 offset:26688
  v_mfma_f32_16x16x32_bf16 v[20:23], a[36:39], v[216:219], v[20:23]
  ds_read_b128 a[32:35], v251 offset:26752
  v_cvt_pk_bf16_f32 v236, v236, v248
  v_mfma_f32_16x16x32_bf16 v[20:23], a[40:43], v[208:211], v[20:23]
  s_waitcnt lgkmcnt(7)
  ds_read_b64 a[60:61], v252 offset:26624
  v_mul_f32 v237, v105, v1
  v_mfma_f32_16x16x32_bf16 v[24:27], a[44:47], v[208:211], v[24:27]
  s_mov_b32 m0, s44
  ds_read_b64 a[64:65], v252 offset:26832
  buffer_load_dwordx4 v254, s[28:31], s43 offen lds
  v_mfma_f32_16x16x32_bf16 v[24:27], a[48:51], v[216:219], v[24:27]
  ds_read_b128 a[44:47], v251 offset:26960
  v_mul_f32 v248, v109, v5
  v_mfma_f32_16x16x32_bf16 v[24:27], a[0:3], v[224:227], v[24:27]
  ds_read_b128 a[48:51], v251 offset:26896
  v_cvt_pk_bf16_f32 v237, v237, v248
  v_mfma_f32_16x16x32_bf16 v[24:27], a[52:55], v[232:235], v[24:27]
  s_waitcnt lgkmcnt(7)
  ds_read_b128 a[0:3], v251 offset:26832
  v_mfma_f32_16x16x32_bf16 v[28:31], a[56:59], v[232:235], v[28:31]
  s_mov_b32 m0, s42
  ds_read_b128 a[4:7], v251 offset:33280
  buffer_load_dwordx4 v254, s[16:19], s41 offen lds
  v_mfma_f32_16x16x32_bf16 v[28:31], a[12:15], v[224:227], v[28:31]
  ds_read_b128 a[8:11], v251 offset:33344
  v_mul_f32 v238, v106, v2
  v_mfma_f32_16x16x32_bf16 v[28:31], a[16:19], v[216:219], v[28:31]
  ds_read_b128 a[12:15], v251 offset:33408
  v_mul_f32 v248, v110, v6
  v_mfma_f32_16x16x32_bf16 v[28:31], a[20:23], v[208:211], v[28:31]
  s_waitcnt lgkmcnt(7)
  ds_read_b64 a[68:69], v252 offset:33280
  v_cvt_pk_bf16_f32 v238, v238, v248
  v_mfma_f32_16x16x32_bf16 v[32:35], a[24:27], v[208:211], v[32:35]
  s_mov_b32 m0, s38
  ds_read_b64 a[72:73], v252 offset:33488
  buffer_load_dwordx4 v253, s[16:19], s37 offen offset:768 lds
  v_mfma_f32_16x16x32_bf16 v[32:35], a[28:31], v[216:219], v[32:35]
  ds_read_b128 a[24:27], v251 offset:33616
  v_mul_f32 v239, v107, v3
  v_mfma_f32_16x16x32_bf16 v[32:35], a[32:35], v[224:227], v[32:35]
  ds_read_b128 a[28:31], v251 offset:33552
  v_mfma_f32_16x16x32_bf16 v[32:35], a[60:63], v[232:235], v[32:35]
  s_waitcnt lgkmcnt(7)
  ds_read_b128 a[32:35], v251 offset:33488
  v_mul_f32 v248, v111, v7
  v_mfma_f32_16x16x32_bf16 v[36:39], a[64:67], v[232:235], v[36:39]
  s_mov_b32 m0, s40
  ds_read_b128 a[36:39], v251 offset:39936
  buffer_load_dwordx4 v253, s[16:19], s39 offen offset:768 lds
  v_mfma_f32_16x16x32_bf16 v[36:39], a[44:47], v[224:227], v[36:39]
  ds_read_b128 a[40:43], v251 offset:40000
  v_cvt_pk_bf16_f32 v239, v239, v248
  v_mfma_f32_16x16x32_bf16 v[36:39], a[48:51], v[216:219], v[36:39]
  ds_read_b128 a[44:47], v251 offset:40064
  v_mul_f32 v240, v112, v8
  v_mfma_f32_16x16x32_bf16 v[36:39], a[0:3], v[208:211], v[36:39]
  s_waitcnt vmcnt(10) lgkmcnt(8)
  ds_read_b64 a[52:53], v252 offset:39936
  v_mul_f32 v248, v116, v12
  v_mfma_f32_16x16x32_bf16 v[40:43], a[4:7], v[208:211], v[40:43]
  s_barrier
  ds_read_b64 a[56:57], v252 offset:40144
  v_add_u32 v252, v252, v255
  v_mfma_f32_16x16x32_bf16 v[40:43], a[8:11], v[216:219], v[40:43]
  ds_read_b128 a[4:7], v251 offset:40272
  v_mfma_f32_16x16x32_bf16 v[40:43], a[12:15], v[224:227], v[40:43]
  s_waitcnt lgkmcnt(7)
  ds_read_b128 a[8:11], v251 offset:40208
  v_cvt_pk_bf16_f32 v240, v240, v248
  v_mfma_f32_16x16x32_bf16 v[40:43], a[68:71], v[232:235], v[40:43]
  s_add_u32 m0, s33, 6656
  ds_read_b128 a[12:15], v251 offset:40144
  buffer_load_dwordx4 v253, s[16:19], s34 offen offset:0 lds
  v_add_u32 v251, 46592, v251
  v_mfma_f32_16x16x32_bf16 v[44:47], a[72:75], v[232:235], v[44:47]
  ds_read_b128 a[16:19], v251 offset:0
  v_mul_f32 v241, v113, v9
  v_mfma_f32_16x16x32_bf16 v[44:47], a[24:27], v[224:227], v[44:47]
  ds_read_b128 a[20:23], v251 offset:64
  v_mul_f32 v248, v117, v13
  v_mfma_f32_16x16x32_bf16 v[44:47], a[28:31], v[216:219], v[44:47]
  s_waitcnt lgkmcnt(7)
  ds_read_b128 a[24:27], v251 offset:128
  v_cvt_pk_bf16_f32 v241, v241, v248
  v_mfma_f32_16x16x32_bf16 v[44:47], a[32:35], v[208:211], v[44:47]
  s_add_u32 m0, s33, 8768
  ds_read_b64 a[60:61], v252 offset:0
  buffer_load_dwordx4 v253, s[16:19], s35 offen offset:0 lds
  v_mfma_f32_16x16x32_bf16 v[48:51], a[36:39], v[208:211], v[48:51]
  ds_read_b64 a[64:65], v252 offset:208
  v_mfma_f32_16x16x32_bf16 v[48:51], a[40:43], v[216:219], v[48:51]
  ds_read_b128 a[36:39], v251 offset:336
  v_mul_f32 v242, v114, v10
  v_mfma_f32_16x16x32_bf16 v[48:51], a[44:47], v[224:227], v[48:51]
  s_waitcnt lgkmcnt(8)
  ds_read_b128 a[40:43], v251 offset:272
  v_mul_f32 v248, v118, v14
  v_mfma_f32_16x16x32_bf16 v[48:51], a[52:55], v[232:235], v[48:51]
  s_add_u32 m0, s33, 10880
  ds_read_b128 a[44:47], v251 offset:208
  buffer_load_dwordx4 v253, s[16:19], s36 offen offset:0 lds
  v_mfma_f32_16x16x32_bf16 v[52:55], a[56:59], v[232:235], v[52:55]
  ds_read_b128 a[48:51], v251 offset:6656
  v_cvt_pk_bf16_f32 v242, v242, v248
  v_mfma_f32_16x16x32_bf16 v[52:55], a[4:7], v[224:227], v[52:55]
  s_waitcnt lgkmcnt(9)
  ds_read_b128 a[0:3], v251 offset:6720
  v_mul_f32 v243, v115, v11
  v_mfma_f32_16x16x32_bf16 v[52:55], a[8:11], v[216:219], v[52:55]
  s_add_u32 m0, s33, 19840
  ds_read_b128 a[4:7], v251 offset:6784
  v_mfma_f32_16x16x32_bf16 v[52:55], a[12:15], v[208:211], v[52:55]
  s_waitcnt vmcnt(8) lgkmcnt(8)
  ds_read_b64 a[68:69], v252 offset:6656
  buffer_load_dwordx4 v253, s[16:19], s34 offen offset:128 lds
  v_mfma_f32_16x16x32_bf16 v[56:59], a[16:19], v[208:211], v[56:59]
  s_barrier
  ds_read_b64 a[72:73], v252 offset:6864
  v_mul_f32 v248, v119, v15
  v_mfma_f32_16x16x32_bf16 v[56:59], a[20:23], v[216:219], v[56:59]
  ds_read_b128 a[16:19], v251 offset:6992
  v_cvt_pk_bf16_f32 v243, v243, v248
  v_mfma_f32_16x16x32_bf16 v[56:59], a[24:27], v[224:227], v[56:59]
  s_waitcnt lgkmcnt(7)
  ds_read_b128 a[20:23], v251 offset:6928
  v_mfma_f32_16x16x32_bf16 v[56:59], a[60:63], v[232:235], v[56:59]
  s_add_u32 m0, s33, 21952
  ds_read_b128 a[24:27], v251 offset:6864
  buffer_load_dwordx4 v253, s[16:19], s35 offen offset:128 lds
  v_mfma_f32_16x16x32_bf16 v[60:63], a[64:67], v[232:235], v[60:63]
  ds_read_b128 a[28:31], v251 offset:13312
  v_mul_f32 v244, v120, v16
  v_mfma_f32_16x16x32_bf16 v[60:63], a[36:39], v[224:227], v[60:63]
  ds_read_b128 a[32:35], v251 offset:13376
  v_mfma_f32_16x16x32_bf16 v[60:63], a[40:43], v[216:219], v[60:63]
  s_waitcnt lgkmcnt(7)
  ds_read_b128 a[36:39], v251 offset:13440
  v_mul_f32 v248, v124, v20
  v_mfma_f32_16x16x32_bf16 v[60:63], a[44:47], v[208:211], v[60:63]
  s_add_u32 m0, s33, 24064
  ds_read_b64 a[52:53], v252 offset:13312
  buffer_load_dwordx4 v253, s[16:19], s36 offen offset:128 lds
  v_mfma_f32_16x16x32_bf16 v[64:67], a[48:51], v[208:211], v[64:67]
  ds_read_b64 a[56:57], v252 offset:13520
  v_mfma_f32_16x16x32_bf16 v[64:67], a[0:3], v[216:219], v[64:67]
  ds_read_b128 a[48:51], v251 offset:13648
  v_mfma_f32_16x16x32_bf16 v[64:67], a[4:7], v[224:227], v[64:67]
  s_waitcnt lgkmcnt(8)
  ds_read_b128 a[0:3], v251 offset:13584
  v_cvt_pk_bf16_f32 v244, v244, v248
  v_mfma_f32_16x16x32_bf16 v[64:67], a[68:71], v[232:235], v[64:67]
  s_add_u32 m0, s33, 33024
  ds_read_b128 a[4:7], v251 offset:13520
  buffer_load_dwordx4 v253, s[16:19], s34 offen offset:256 lds
  v_mfma_f32_16x16x32_bf16 v[68:71], a[72:75], v[232:235], v[68:71]
  ds_read_b128 a[8:11], v251 offset:19968
  v_mfma_f32_16x16x32_bf16 v[68:71], a[16:19], v[224:227], v[68:71]
  s_waitcnt lgkmcnt(9)
  ds_read_b128 a[12:15], v251 offset:20032
  v_mul_f32 v245, v121, v17
  v_mfma_f32_16x16x32_bf16 v[68:71], a[20:23], v[216:219], v[68:71]
  s_add_u32 m0, s33, 35136
  ds_read_b128 a[16:19], v251 offset:20096
  v_mfma_f32_16x16x32_bf16 v[68:71], a[24:27], v[208:211], v[68:71]
  s_waitcnt vmcnt(10) lgkmcnt(8)
  ds_read_b64 a[60:61], v252 offset:19968
  buffer_load_dwordx4 v253, s[16:19], s35 offen offset:256 lds
  v_mfma_f32_16x16x32_bf16 v[72:75], a[28:31], v[208:211], v[72:75]
  s_barrier
  ds_read_b64 a[64:65], v252 offset:20176
  v_mfma_f32_16x16x32_bf16 v[72:75], a[32:35], v[216:219], v[72:75]
  ds_read_b128 a[28:31], v251 offset:20304
  v_mul_f32 v248, v125, v21
  v_mfma_f32_16x16x32_bf16 v[72:75], a[36:39], v[224:227], v[72:75]
  s_waitcnt lgkmcnt(7)
  ds_read_b128 a[32:35], v251 offset:20240
  v_mfma_f32_16x16x32_bf16 v[72:75], a[52:55], v[232:235], v[72:75]
  s_add_u32 m0, s33, 37248
  ds_read_b128 a[36:39], v251 offset:20176
  buffer_load_dwordx4 v253, s[16:19], s36 offen offset:256 lds
  v_mfma_f32_16x16x32_bf16 v[76:79], a[56:59], v[232:235], v[76:79]
  ds_read_b128 a[40:43], v251 offset:26624
  v_cvt_pk_bf16_f32 v245, v245, v248
  v_mfma_f32_16x16x32_bf16 v[76:79], a[48:51], v[224:227], v[76:79]
  ds_read_b128 a[44:47], v251 offset:26688
  v_mfma_f32_16x16x32_bf16 v[76:79], a[0:3], v[216:219], v[76:79]
  s_waitcnt lgkmcnt(7)
  ds_read_b128 a[48:51], v251 offset:26752
  v_mfma_f32_16x16x32_bf16 v[76:79], a[4:7], v[208:211], v[76:79]
  s_add_u32 m0, s33, 46208
  ds_read_b64 a[68:69], v252 offset:26624
  buffer_load_dwordx4 v253, s[16:19], s34 offen offset:384 lds
  v_mfma_f32_16x16x32_bf16 v[80:83], a[8:11], v[208:211], v[80:83]
  ds_read_b64 a[72:73], v252 offset:26832
  v_mul_f32 v246, v122, v18
  v_mfma_f32_16x16x32_bf16 v[80:83], a[12:15], v[216:219], v[80:83]
  ds_read_b128 a[8:11], v251 offset:26960
  v_mfma_f32_16x16x32_bf16 v[80:83], a[16:19], v[224:227], v[80:83]
  s_waitcnt lgkmcnt(8)
  ds_read_b128 a[12:15], v251 offset:26896
  v_mul_f32 v248, v126, v22
  v_mfma_f32_16x16x32_bf16 v[80:83], a[60:63], v[232:235], v[80:83]
  s_add_u32 m0, s33, 48320
  ds_read_b128 a[16:19], v251 offset:26832
  buffer_load_dwordx4 v253, s[16:19], s35 offen offset:384 lds
  v_mfma_f32_16x16x32_bf16 v[84:87], a[64:67], v[232:235], v[84:87]
  ds_read_b128 a[20:23], v251 offset:33280
  v_mfma_f32_16x16x32_bf16 v[84:87], a[28:31], v[224:227], v[84:87]
  s_waitcnt lgkmcnt(9)
  ds_read_b128 a[24:27], v251 offset:33344
  v_mfma_f32_16x16x32_bf16 v[84:87], a[32:35], v[216:219], v[84:87]
  s_add_u32 m0, s33, 50432
  ds_read_b128 a[28:31], v251 offset:33408
  v_cvt_pk_bf16_f32 v246, v246, v248
  v_mfma_f32_16x16x32_bf16 v[84:87], a[36:39], v[208:211], v[84:87]
  s_waitcnt vmcnt(8) lgkmcnt(8)
  ds_read_b64 a[52:53], v252 offset:33280
  buffer_load_dwordx4 v253, s[16:19], s36 offen offset:384 lds
  v_mfma_f32_16x16x32_bf16 v[88:91], a[40:43], v[208:211], v[88:91]
  s_barrier
  ds_read_b64 a[56:57], v252 offset:33488
  v_mfma_f32_16x16x32_bf16 v[88:91], a[44:47], v[216:219], v[88:91]
  ds_read_b128 a[40:43], v251 offset:33616
  v_mul_f32 v247, v123, v19
  v_mfma_f32_16x16x32_bf16 v[88:91], a[48:51], v[224:227], v[88:91]
  s_waitcnt lgkmcnt(7)
  ds_read_b128 a[44:47], v251 offset:33552
  v_mfma_f32_16x16x32_bf16 v[88:91], a[68:71], v[232:235], v[88:91]
  s_add_u32 m0, s33, 59392
  ds_read_b128 a[48:51], v251 offset:33488
  buffer_load_dwordx4 v253, s[16:19], s34 offen offset:512 lds
  v_subrev_u32 v251, 46592, v251
  v_mfma_f32_16x16x32_bf16 v[92:95], a[72:75], v[232:235], v[92:95]
  ds_read_b128 a[0:3], v249 offset:44544
  v_mfma_f32_16x16x32_bf16 v[92:95], a[8:11], v[224:227], v[92:95]
  ds_read_b128 a[4:7], v249 offset:51200
  v_mul_f32 v248, v127, v23
  v_mfma_f32_16x16x32_bf16 v[92:95], a[12:15], v[216:219], v[92:95]
  s_waitcnt lgkmcnt(7)
  ds_read_b128 a[8:11], v249 offset:57856
  v_subrev_u32 v249, 46592, v249
  v_mfma_f32_16x16x32_bf16 v[92:95], a[16:19], v[208:211], v[92:95]
  s_add_u32 m0, s33, 61504
  ds_read_b128 a[12:15], v249 offset:6656
  buffer_load_dwordx4 v253, s[16:19], s35 offen offset:512 lds
  v_mfma_f32_16x16x32_bf16 v[96:99], a[20:23], v[208:211], v[96:99]
  ds_read_b128 a[16:19], v249 offset:8768
  v_mfma_f32_16x16x32_bf16 v[96:99], a[24:27], v[216:219], v[96:99]
  ds_read_b128 a[20:23], v249 offset:10880
  v_cvt_pk_bf16_f32 v247, v247, v248
  v_mfma_f32_16x16x32_bf16 v[96:99], a[28:31], v[224:227], v[96:99]
  s_waitcnt lgkmcnt(7)
  ds_read_b128 a[24:27], v250 offset:0
  v_mfma_f32_16x16x32_bf16 v[96:99], a[52:55], v[232:235], v[96:99]
  s_add_u32 m0, s33, 63616
  ds_read_b128 a[28:31], v250 offset:64
  buffer_load_dwordx4 v253, s[16:19], s36 offen offset:512 lds
  v_mfma_f32_16x16x32_bf16 v[100:103], a[56:59], v[232:235], v[100:103]
  ds_read_b128 a[32:35], v249 offset:17536
  v_mfma_f32_16x16x32_bf16 v[100:103], a[40:43], v[224:227], v[100:103]
  ds_read_b128 a[36:39], v249 offset:10944
  v_mfma_f32_16x16x32_bf16 v[100:103], a[44:47], v[216:219], v[100:103]
  s_waitcnt lgkmcnt(8)
  ds_read_b128 a[40:43], v249 offset:15424
  v_mfma_f32_16x16x32_bf16 v[100:103], a[48:51], v[208:211], v[100:103]
  ds_read_b128 a[44:47], v249 offset:8832
  v_mfma_f32_16x16x32_bf16 v[212:215], a[0:3], v[236:239], 0
  ds_read_b128 a[48:51], v249 offset:13312
  v_accvgpr_read_b32 v248, a77
  v_mfma_f32_16x16x32_bf16 v[220:223], a[4:7], v[236:239], 0
  s_waitcnt vmcnt(6) lgkmcnt(8)
  ds_read_b128 a[0:3], v249 offset:6720
  v_add_u32 v252, v252, v248
  v_mfma_f32_16x16x32_bf16 v[228:231], a[8:11], v[236:239], 0
  s_barrier
  ds_read_b128 a[4:7], v249 offset:19968
  v_add_u32 v254, 86528, v254
  v_mfma_f32_16x16x32_bf16 v[208:211], a[12:15], v[236:239], 0
  ds_read_b128 a[8:11], v249 offset:13376
  v_mfma_f32_16x16x32_bf16 v[216:219], a[16:19], v[236:239], 0
  s_waitcnt lgkmcnt(7)
  ds_read_b128 a[12:15], v249 offset:22080
  v_mfma_f32_16x16x32_bf16 v[224:227], a[20:23], v[236:239], 0
  s_add_u32 m0, s33, 72576
  ds_read_b128 a[16:19], v249 offset:15488
  buffer_load_dwordx4 v253, s[16:19], s34 offen offset:640 lds
  v_mfma_f32_16x16x32_bf16 v[232:235], a[24:27], v[236:239], 0
  ds_read_b128 a[20:23], v249 offset:24192
  v_mfma_f32_16x16x32_bf16 v[232:235], a[28:31], v[240:243], v[232:235]
  ds_read_b128 a[24:27], v249 offset:17600
  v_mul_f32 v236, v128, v24
  v_mul_f32 v248, v132, v28
  v_mfma_f32_16x16x32_bf16 v[228:231], a[32:35], v[240:243], v[228:231]
  s_waitcnt lgkmcnt(7)
  ds_read_b128 a[28:31], v250 offset:128
  v_cvt_pk_bf16_f32 v236, v236, v248
  v_mul_f32 v237, v129, v25
  v_mfma_f32_16x16x32_bf16 v[224:227], a[36:39], v[240:243], v[224:227]
  s_add_u32 m0, s33, 74688
  ds_read_b128 a[32:35], v250 offset:192
  buffer_load_dwordx4 v253, s[16:19], s35 offen offset:640 lds
  v_mfma_f32_16x16x32_bf16 v[220:223], a[40:43], v[240:243], v[220:223]
  ds_read_b128 a[36:39], v249 offset:30848
  v_mul_f32 v248, v133, v29
  v_cvt_pk_bf16_f32 v237, v237, v248
  v_mfma_f32_16x16x32_bf16 v[216:219], a[44:47], v[240:243], v[216:219]
  ds_read_b128 a[40:43], v249 offset:24256
  v_mul_f32 v238, v130, v26
  v_mul_f32 v248, v134, v30
  v_mfma_f32_16x16x32_bf16 v[212:215], a[48:51], v[240:243], v[212:215]
  s_waitcnt lgkmcnt(7)
  ds_read_b128 a[44:47], v249 offset:28736
  v_cvt_pk_bf16_f32 v238, v238, v248
  v_mul_f32 v239, v131, v27
  v_mfma_f32_16x16x32_bf16 v[208:211], a[0:3], v[240:243], v[208:211]
  s_add_u32 m0, s33, 76800
  ds_read_b128 a[48:51], v249 offset:22144
  buffer_load_dwordx4 v253, s[16:19], s36 offen offset:640 lds
  v_mfma_f32_16x16x32_bf16 v[208:211], a[4:7], v[244:247], v[208:211]
  ds_read_b128 a[0:3], v249 offset:26624
  v_mul_f32 v248, v135, v31
  v_cvt_pk_bf16_f32 v239, v239, v248
  v_mfma_f32_16x16x32_bf16 v[212:215], a[8:11], v[244:247], v[212:215]
  ds_read_b128 a[4:7], v249 offset:20032
  v_mul_f32 v240, v136, v32
  v_mul_f32 v248, v140, v36
  v_mfma_f32_16x16x32_bf16 v[216:219], a[12:15], v[244:247], v[216:219]
  s_waitcnt lgkmcnt(8)
  ds_read_b128 a[8:11], v249 offset:33280
  v_cvt_pk_bf16_f32 v240, v240, v248
  v_mfma_f32_16x16x32_bf16 v[220:223], a[16:19], v[244:247], v[220:223]
  ds_read_b128 a[12:15], v249 offset:26688
  v_mul_f32 v241, v137, v33
  v_mul_f32 v248, v141, v37
  v_mfma_f32_16x16x32_bf16 v[224:227], a[20:23], v[244:247], v[224:227]
  ds_read_b128 a[16:19], v249 offset:35392
  v_cvt_pk_bf16_f32 v241, v241, v248
  v_mul_f32 v242, v138, v34
  v_mfma_f32_16x16x32_bf16 v[228:231], a[24:27], v[244:247], v[228:231]
  s_waitcnt vmcnt(6) lgkmcnt(8)
  ds_read_b128 a[20:23], v249 offset:28800
  v_mul_f32 v248, v142, v38
  v_cvt_pk_bf16_f32 v242, v242, v248
  v_mfma_f32_16x16x32_bf16 v[232:235], a[28:31], v[244:247], v[232:235]
  s_barrier
  ds_read_b128 a[24:27], v249 offset:37504
  v_mul_f32 v243, v139, v35
  v_mfma_f32_16x16x32_bf16 v[232:235], a[32:35], v[236:239], v[232:235]
  ds_read_b128 a[28:31], v249 offset:30912
  v_mul_f32 v248, v143, v39
  v_cvt_pk_bf16_f32 v243, v243, v248
  v_mfma_f32_16x16x32_bf16 v[228:231], a[36:39], v[236:239], v[228:231]
  s_waitcnt lgkmcnt(7)
  ds_read_b128 a[32:35], v250 offset:256
  v_mul_f32 v244, v144, v40
  v_mul_f32 v248, v148, v44
  v_mfma_f32_16x16x32_bf16 v[224:227], a[40:43], v[236:239], v[224:227]
  s_add_u32 m0, s45, 0
  ds_read_b128 a[36:39], v250 offset:320
  buffer_load_dwordx4 v254, s[12:15], m0 offen offset:0 lds
  v_cvt_pk_bf16_f32 v244, v244, v248
  v_mfma_f32_16x16x32_bf16 v[220:223], a[44:47], v[236:239], v[220:223]
  ds_read_b128 a[40:43], v249 offset:44160
  v_mul_f32 v245, v145, v41
  v_mfma_f32_16x16x32_bf16 v[216:219], a[48:51], v[236:239], v[216:219]
  ds_read_b128 a[44:47], v249 offset:37568
  v_mul_f32 v248, v149, v45
  v_cvt_pk_bf16_f32 v245, v245, v248
  v_mfma_f32_16x16x32_bf16 v[212:215], a[0:3], v[236:239], v[212:215]
  s_waitcnt lgkmcnt(7)
  ds_read_b128 a[48:51], v249 offset:42048
  v_mul_f32 v246, v146, v42
  v_mul_f32 v248, v150, v46
  v_mfma_f32_16x16x32_bf16 v[208:211], a[4:7], v[236:239], v[208:211]
  ds_read_b128 a[0:3], v249 offset:35456
  buffer_load_dwordx4 v254, s[12:15], m0 offen offset:1024 lds
  v_cvt_pk_bf16_f32 v246, v246, v248
  v_mfma_f32_16x16x32_bf16 v[208:211], a[8:11], v[240:243], v[208:211]
  ds_read_b128 a[4:7], v249 offset:39936
  v_mul_f32 v247, v147, v43
  v_mfma_f32_16x16x32_bf16 v[212:215], a[12:15], v[240:243], v[212:215]
  ds_read_b128 a[8:11], v249 offset:33344
  v_mul_f32 v248, v151, v47
  v_cvt_pk_bf16_f32 v247, v247, v248
  v_mfma_f32_16x16x32_bf16 v[216:219], a[16:19], v[240:243], v[216:219]
  s_waitcnt lgkmcnt(8)
  ds_read_b128 a[12:15], v249 offset:46592
  v_mul_f32 v236, v152, v48
  v_mul_f32 v248, v156, v52
  v_mfma_f32_16x16x32_bf16 v[220:223], a[20:23], v[240:243], v[220:223]
  ds_read_b128 a[16:19], v249 offset:40000
  buffer_load_dwordx4 v254, s[12:15], m0 offen offset:2048 lds
  v_cvt_pk_bf16_f32 v236, v236, v248
  v_mfma_f32_16x16x32_bf16 v[224:227], a[24:27], v[240:243], v[224:227]
  ds_read_b128 a[20:23], v249 offset:48704
  v_mul_f32 v237, v153, v49
  v_mul_f32 v248, v157, v53
  v_mfma_f32_16x16x32_bf16 v[228:231], a[28:31], v[240:243], v[228:231]
  s_waitcnt vmcnt(6) lgkmcnt(7)
  ds_read_b128 a[24:27], v249 offset:42112
  v_cvt_pk_bf16_f32 v237, v237, v248
  v_mul_f32 v238, v154, v50
  v_mfma_f32_16x16x32_bf16 v[232:235], a[32:35], v[240:243], v[232:235]
  s_barrier
  ds_read_b128 a[28:31], v249 offset:50816
  v_mul_f32 v248, v158, v54
  v_cvt_pk_bf16_f32 v238, v238, v248
  v_mfma_f32_16x16x32_bf16 v[232:235], a[36:39], v[244:247], v[232:235]
  ds_read_b128 a[32:35], v249 offset:44224
  buffer_load_dwordx4 v254, s[12:15], m0 offen offset:3072 lds
  v_mul_f32 v239, v155, v51
  v_mfma_f32_16x16x32_bf16 v[228:231], a[40:43], v[244:247], v[228:231]
  ds_read_b128 a[36:39], v250 offset:384
  v_mul_f32 v248, v159, v55
  v_cvt_pk_bf16_f32 v239, v239, v248
  v_mfma_f32_16x16x32_bf16 v[224:227], a[44:47], v[244:247], v[224:227]
  s_waitcnt lgkmcnt(7)
  ds_read_b128 a[40:43], v250 offset:448
  v_mul_f32 v240, v160, v56
  v_mul_f32 v248, v164, v60
  v_mfma_f32_16x16x32_bf16 v[220:223], a[48:51], v[244:247], v[220:223]
  ds_read_b128 a[44:47], v249 offset:57472
  v_cvt_pk_bf16_f32 v240, v240, v248
  v_mul_f32 v241, v161, v57
  v_mfma_f32_16x16x32_bf16 v[216:219], a[0:3], v[244:247], v[216:219]
  s_add_u32 m0, s45, 16384
  ds_read_b128 a[48:51], v249 offset:50880
  buffer_load_dwordx4 v254, s[12:15], m0 offen offset:0 lds
  v_mul_f32 v248, v165, v61
  v_mfma_f32_16x16x32_bf16 v[212:215], a[4:7], v[244:247], v[212:215]
  ds_read_b128 a[0:3], v249 offset:55360
  v_cvt_pk_bf16_f32 v241, v241, v248
  v_mfma_f32_16x16x32_bf16 v[208:211], a[8:11], v[244:247], v[208:211]
  s_waitcnt lgkmcnt(7)
  ds_read_b128 a[4:7], v249 offset:48768
  v_mul_f32 v242, v162, v58
  v_mul_f32 v248, v166, v62
  v_mfma_f32_16x16x32_bf16 v[208:211], a[12:15], v[236:239], v[208:211]
  ds_read_b128 a[8:11], v249 offset:53248
  v_cvt_pk_bf16_f32 v242, v242, v248
  v_mul_f32 v243, v163, v59
  v_mfma_f32_16x16x32_bf16 v[212:215], a[16:19], v[236:239], v[212:215]
  ds_read_b128 a[12:15], v249 offset:46656
  buffer_load_dwordx4 v254, s[12:15], m0 offen offset:1024 lds
  v_add_u32 v249, 46592, v249
  v_mfma_f32_16x16x32_bf16 v[216:219], a[20:23], v[236:239], v[216:219]
  ds_read_b128 a[16:19], v249 offset:13312
  v_mul_f32 v248, v167, v63
  v_cvt_pk_bf16_f32 v243, v243, v248
  v_mfma_f32_16x16x32_bf16 v[220:223], a[24:27], v[236:239], v[220:223]
  s_waitcnt lgkmcnt(7)
  ds_read_b128 a[20:23], v249 offset:6720
  v_mul_f32 v244, v168, v64
  v_mul_f32 v248, v172, v68
  v_mfma_f32_16x16x32_bf16 v[224:227], a[28:31], v[236:239], v[224:227]
  ds_read_b128 a[24:27], v249 offset:15424
  v_cvt_pk_bf16_f32 v244, v244, v248
  v_mul_f32 v245, v169, v65
  v_mfma_f32_16x16x32_bf16 v[228:231], a[32:35], v[236:239], v[228:231]
  ds_read_b128 a[28:31], v249 offset:8832
  buffer_load_dwordx4 v254, s[12:15], m0 offen offset:2048 lds
  v_mfma_f32_16x16x32_bf16 v[232:235], a[36:39], v[236:239], v[232:235]
  ds_read_b128 a[32:35], v249 offset:17536
  v_mul_f32 v248, v173, v69
  v_cvt_pk_bf16_f32 v245, v245, v248
  v_mfma_f32_16x16x32_bf16 v[232:235], a[40:43], v[240:243], v[232:235]
  s_waitcnt lgkmcnt(7)
  ds_read_b128 a[36:39], v249 offset:10944
  v_mul_f32 v246, v170, v66
  v_mul_f32 v248, v174, v70
  v_mfma_f32_16x16x32_bf16 v[228:231], a[44:47], v[240:243], v[228:231]
  ds_read_b128 a[40:43], v250 offset:512
  v_cvt_pk_bf16_f32 v246, v246, v248
  v_mul_f32 v247, v171, v67
  v_mfma_f32_16x16x32_bf16 v[224:227], a[48:51], v[240:243], v[224:227]
  ds_read_b128 a[44:47], v250 offset:576
  buffer_load_dwordx4 v254, s[12:15], m0 offen offset:3072 lds
  v_mfma_f32_16x16x32_bf16 v[220:223], a[0:3], v[240:243], v[220:223]
  ds_read_b128 a[48:51], v249 offset:24192
  v_mul_f32 v248, v175, v71
  v_cvt_pk_bf16_f32 v247, v247, v248
  v_mfma_f32_16x16x32_bf16 v[216:219], a[4:7], v[240:243], v[216:219]
  s_waitcnt vmcnt(8) lgkmcnt(8)
  ds_read_b128 a[0:3], v249 offset:17600
  v_mul_f32 v236, v176, v72
  v_mul_f32 v248, v180, v76
  v_mfma_f32_16x16x32_bf16 v[212:215], a[8:11], v[240:243], v[212:215]
  s_barrier
  ds_read_b128 a[4:7], v249 offset:22080
  v_cvt_pk_bf16_f32 v236, v236, v248
  v_mul_f32 v237, v177, v73
  v_mfma_f32_16x16x32_bf16 v[208:211], a[12:15], v[240:243], v[208:211]
  ds_read_b128 a[8:11], v249 offset:15488
  v_mul_f32 v248, v181, v77
  v_cvt_pk_bf16_f32 v237, v237, v248
  v_mfma_f32_16x16x32_bf16 v[208:211], a[16:19], v[244:247], v[208:211]
  s_waitcnt lgkmcnt(7)
  ds_read_b128 a[12:15], v249 offset:19968
  v_mul_f32 v238, v178, v74
  v_mfma_f32_16x16x32_bf16 v[212:215], a[20:23], v[244:247], v[212:215]
  s_add_u32 m0, s45, 32768
  ds_read_b128 a[16:19], v249 offset:13376
  buffer_load_dwordx4 v254, s[12:15], m0 offen offset:0 lds
  v_mul_f32 v248, v182, v78
  v_mfma_f32_16x16x32_bf16 v[216:219], a[24:27], v[244:247], v[216:219]
  ds_read_b128 a[20:23], v249 offset:26624
  v_cvt_pk_bf16_f32 v238, v238, v248
  v_mul_f32 v239, v179, v75
  v_mfma_f32_16x16x32_bf16 v[220:223], a[28:31], v[244:247], v[220:223]
L_tB0:
  s_cbranch_execz L_tret
  ds_read_b128 a[24:27], v249 offset:20032
  v_mul_f32 v248, v183, v79
  v_cvt_pk_bf16_f32 v239, v239, v248
  v_mfma_f32_16x16x32_bf16 v[224:227], a[32:35], v[244:247], v[224:227]
  s_waitcnt lgkmcnt(7)
  ds_read_b128 a[28:31], v249 offset:28736
  v_mul_f32 v240, v184, v80
  v_mul_f32 v248, v188, v84
  v_mfma_f32_16x16x32_bf16 v[228:231], a[36:39], v[244:247], v[228:231]
  ds_read_b128 a[32:35], v249 offset:22144
  buffer_load_dwordx4 v254, s[12:15], m0 offen offset:1024 lds
  v_cvt_pk_bf16_f32 v240, v240, v248
  v_mfma_f32_16x16x32_bf16 v[232:235], a[40:43], v[244:247], v[232:235]
  ds_read_b128 a[36:39], v249 offset:30848
  v_mul_f32 v241, v185, v81
  v_mfma_f32_16x16x32_bf16 v[232:235], a[44:47], v[236:239], v[232:235]
  ds_read_b128 a[40:43], v249 offset:24256
  v_mul_f32 v248, v189, v85
  v_cvt_pk_bf16_f32 v241, v241, v248
  v_mfma_f32_16x16x32_bf16 v[228:231], a[48:51], v[236:239], v[228:231]
  s_waitcnt lgkmcnt(8)
  ds_read_b128 a[44:47], v250 offset:640
  v_mul_f32 v242, v186, v82
  v_mul_f32 v248, v190, v86
  v_mfma_f32_16x16x32_bf16 v[224:227], a[0:3], v[236:239], v[224:227]
  ds_read_b128 a[48:51], v250 offset:704
  buffer_load_dwordx4 v254, s[12:15], m0 offen offset:2048 lds
  v_cvt_pk_bf16_f32 v242, v242, v248
  v_mfma_f32_16x16x32_bf16 v[220:223], a[4:7], v[236:239], v[220:223]
  ds_read_b128 a[0:3], v249 offset:37504
  v_mul_f32 v243, v187, v83
  v_mfma_f32_16x16x32_bf16 v[216:219], a[8:11], v[236:239], v[216:219]
  s_waitcnt vmcnt(7) lgkmcnt(7)
  ds_read_b128 a[4:7], v249 offset:30912
  v_mul_f32 v248, v191, v87
  v_cvt_pk_bf16_f32 v243, v243, v248
  v_mfma_f32_16x16x32_bf16 v[212:215], a[12:15], v[236:239], v[212:215]
  s_barrier
  ds_read_b128 a[8:11], v249 offset:35392
  buffer_load_dword a87, v254, s[12:15], s5 offen
  v_mul_f32 v244, v192, v88
  v_mfma_f32_16x16x32_bf16 v[208:211], a[16:19], v[236:239], v[208:211]
  ds_read_b128 a[12:15], v249 offset:28800
  buffer_load_dwordx4 v254, s[12:15], m0 offen offset:3072 lds
  v_mul_f32 v248, v196, v92
  v_mfma_f32_16x16x32_bf16 v[208:211], a[20:23], v[240:243], v[208:211]
  ds_read_b128 a[16:19], v249 offset:33280
  v_cvt_pk_bf16_f32 v244, v244, v248
  v_mul_f32 v245, v193, v89
  v_mfma_f32_16x16x32_bf16 v[212:215], a[24:27], v[240:243], v[212:215]
  s_waitcnt lgkmcnt(7)
  ds_read_b128 a[20:23], v249 offset:26688
  v_mul_f32 v248, v197, v93
  v_cvt_pk_bf16_f32 v245, v245, v248
  v_mul_f32 v246, v194, v90
  v_mfma_f32_16x16x32_bf16 v[216:219], a[28:31], v[240:243], v[216:219]
  ds_read_b128 a[24:27], v249 offset:44480
  v_mul_f32 v248, v198, v94
  v_cvt_pk_bf16_f32 v246, v246, v248
  v_mfma_f32_16x16x32_bf16 v[220:223], a[32:35], v[240:243], v[220:223]
  s_add_u32 m0, s45, 49152
  ds_read_b128 a[28:31], v249 offset:33344
  buffer_load_dwordx4 v254, s[12:15], m0 offen offset:0 lds
  v_mul_f32 v247, v195, v91
  v_mfma_f32_16x16x32_bf16 v[224:227], a[36:39], v[240:243], v[224:227]
  ds_read_b128 a[32:35], v249 offset:51136
  v_mul_f32 v248, v199, v95
  v_cvt_pk_bf16_f32 v247, v247, v248
  v_mfma_f32_16x16x32_bf16 v[228:231], a[40:43], v[240:243], v[228:231]
  s_waitcnt lgkmcnt(7)
  ds_read_b128 a[36:39], v249 offset:35456
  v_mul_f32 v236, v200, v96
  v_mul_f32 v248, v204, v100
  v_mfma_f32_16x16x32_bf16 v[232:235], a[44:47], v[240:243], v[232:235]
  ds_read_b128 a[40:43], v249 offset:57792
  v_cvt_pk_bf16_f32 v236, v236, v248
  v_mul_f32 v237, v201, v97
  v_mfma_f32_16x16x32_bf16 v[232:235], a[48:51], v[244:247], v[232:235]
  ds_read_b128 a[44:47], v249 offset:37568
  buffer_load_dwordx4 v254, s[12:15], m0 offen offset:1024 lds
  v_mfma_f32_16x16x32_bf16 v[228:231], a[0:3], v[244:247], v[228:231]
  ds_read_b128 a[48:51], v250 offset:768
  v_mul_f32 v248, v205, v101
  v_cvt_pk_bf16_f32 v237, v237, v248
  v_mfma_f32_16x16x32_bf16 v[224:227], a[4:7], v[244:247], v[224:227]
  s_waitcnt lgkmcnt(7)
  ds_read_b128 a[0:3], v251 offset:0
  v_mul_f32 v238, v202, v98
  v_mul_f32 v248, v206, v102
  v_mfma_f32_16x16x32_bf16 v[220:223], a[8:11], v[244:247], v[220:223]
  ds_read_b128 a[4:7], v251 offset:208
  v_cvt_pk_bf16_f32 v238, v238, v248
  v_mul_f32 v239, v203, v99
  v_mfma_f32_16x16x32_bf16 v[216:219], a[12:15], v[244:247], v[216:219]
  ds_read_b128 a[8:11], v251 offset:6656
  buffer_load_dwordx4 v254, s[12:15], m0 offen offset:2048 lds
  v_mfma_f32_16x16x32_bf16 v[212:215], a[16:19], v[244:247], v[212:215]
  ds_read_b128 a[12:15], v251 offset:6864
  v_mul_f32 v248, v207, v103
  v_cvt_pk_bf16_f32 v239, v239, v248
  v_mfma_f32_16x16x32_bf16 v[208:211], a[20:23], v[244:247], v[208:211]
  s_waitcnt lgkmcnt(7)
  ds_read_b128 a[16:19], v251 offset:64
  v_mfma_f32_16x16x32_bf16 v[208:211], a[24:27], v[236:239], v[208:211]
  ds_read_b128 a[20:23], v251 offset:272
  v_mfma_f32_16x16x32_bf16 v[212:215], a[28:31], v[236:239], v[212:215]
  ds_read_b128 a[24:27], v251 offset:6720
  buffer_load_dwordx4 v254, s[12:15], m0 offen offset:3072 lds
  v_mfma_f32_16x16x32_bf16 v[216:219], a[32:35], v[236:239], v[216:219]
  ds_read_b128 a[28:31], v251 offset:6928
  v_add_u32 v253, 86528, v253
  v_mfma_f32_16x16x32_bf16 v[220:223], a[36:39], v[236:239], v[220:223]
  s_waitcnt lgkmcnt(8)
  ds_read_b128 a[32:35], v251 offset:128
  v_mfma_f32_16x16x32_bf16 v[224:227], a[40:43], v[236:239], v[224:227]
  ds_read_b128 a[36:39], v251 offset:336
  v_cvt_pk_bf16_f32 v208, v208, v212
  v_cvt_pk_bf16_f32 v209, v209, v213
  v_mfma_f32_16x16x32_bf16 v[228:231], a[44:47], v[236:239], v[228:231]
  ds_read_b128 a[40:43], v251 offset:6784
  v_cvt_pk_bf16_f32 v210, v210, v214
  v_cvt_pk_bf16_f32 v211, v211, v215
  v_mfma_f32_16x16x32_bf16 v[232:235], a[48:51], v[236:239], v[232:235]
  s_waitcnt vmcnt(9) lgkmcnt(7)
  s_sub_u32 s47, s47, 1
  ds_read_b128 a[44:47], v251 offset:6992
  s_cbranch_scc0 L_loop1
  s_branch L_g2l
.p2align 12
L_tG:
  s_branch L_tA0
L_g2l:
  v_mfma_f32_16x16x32_bf16 v[0:3], a[0:3], v[208:211], v[0:3]
  s_barrier
  ds_read_b64 a[52:53], v252 offset:0
  v_cvt_pk_bf16_f32 v216, v216, v220
  v_cvt_pk_bf16_f32 v217, v217, v221
  v_mfma_f32_16x16x32_bf16 v[4:7], a[4:7], v[208:211], v[4:7]
  s_add_u32 m0, s45, 65536
  ds_read_b64 a[56:57], v252 offset:208
  buffer_load_dwordx4 v254, s[12:15], m0 offen offset:0 lds
  v_accvgpr_read_b32 v253, a76
  v_mfma_f32_16x16x32_bf16 v[8:11], a[8:11], v[208:211], v[8:11]
  ds_read_b64 a[60:61], v252 offset:6656
  v_cvt_pk_bf16_f32 v218, v218, v222
  v_cvt_pk_bf16_f32 v219, v219, v223
  v_accvgpr_read_b32 v249, a81
  v_mfma_f32_16x16x32_bf16 v[12:15], a[12:15], v[208:211], v[12:15]
  s_waitcnt lgkmcnt(7)
  ds_read_b64 a[64:65], v252 offset:6864
  v_cvt_pk_bf16_f32 v224, v224, v228
  s_mov_b32 vcc_lo, 0x55555555
  v_mfma_f32_16x16x32_bf16 v[0:3], a[16:19], v[216:219], v[0:3]
  ds_read_b128 a[12:15], v251 offset:13312
  v_cvt_pk_bf16_f32 v225, v225, v229
  v_cvt_pk_bf16_f32 v226, v226, v230
  s_mov_b32 vcc_hi, 0x55555555
  v_mfma_f32_16x16x32_bf16 v[4:7], a[20:23], v[216:219], v[4:7]
  ds_read_b128 a[16:19], v251 offset:13376
  buffer_load_dwordx4 v254, s[12:15], m0 offen offset:1024 lds
  v_mfma_f32_16x16x32_bf16 v[8:11], a[24:27], v[216:219], v[8:11]
  ds_read_b128 a[20:23], v251 offset:13440
  v_cvt_pk_bf16_f32 v227, v227, v231
  v_mfma_f32_16x16x32_bf16 v[12:15], a[28:31], v[216:219], v[12:15]
  s_waitcnt lgkmcnt(7)
  ds_read_b64 a[68:69], v252 offset:13312
  v_cvt_pk_bf16_f32 v232, v232, v233
  v_cvt_pk_bf16_f32 v233, v234, v235
  v_mfma_f32_16x16x32_bf16 v[0:3], a[32:35], v[224:227], v[0:3]
  ds_read_b64 a[72:73], v252 offset:13520
  v_mov_b32 v234, 0
  v_mfma_f32_16x16x32_bf16 v[4:7], a[36:39], v[224:227], v[4:7]
  ds_read_b128 a[32:35], v251 offset:13648
  buffer_load_dwordx4 v254, s[12:15], m0 offen offset:2048 lds
  v_mov_b32 v235, 0
  v_mfma_f32_16x16x32_bf16 v[8:11], a[40:43], v[224:227], v[8:11]
  ds_read_b128 a[36:39], v251 offset:13584
  v_cndmask_b32_e64 v232, v232, 0.5, s[54:55]
  v_mfma_f32_16x16x32_bf16 v[12:15], a[44:47], v[224:227], v[12:15]
  s_waitcnt lgkmcnt(7)
  ds_read_b128 a[40:43], v251 offset:13520
  v_mfma_f32_16x16x32_bf16 v[0:3], a[52:55], v[232:235], v[0:3]
  ds_read_b128 a[44:47], v251 offset:19968
  v_mfma_f32_16x16x32_bf16 v[4:7], a[56:59], v[232:235], v[4:7]
  ds_read_b128 a[48:51], v251 offset:20032
  buffer_load_dwordx4 v254, s[12:15], m0 offen offset:3072 lds
  v_mfma_f32_16x16x32_bf16 v[8:11], a[60:63], v[232:235], v[8:11]
  ds_read_b128 a[0:3], v251 offset:20096
  v_mfma_f32_16x16x32_bf16 v[12:15], a[64:67], v[232:235], v[12:15]
  s_waitcnt lgkmcnt(7)
  ds_read_b64 a[52:53], v252 offset:19968
  v_mfma_f32_16x16x32_bf16 v[16:19], a[12:15], v[208:211], v[16:19]
  ds_read_b64 a[56:57], v252 offset:20176
  v_mul_f32 v104, v104, v0
  v_mul_f32 v248, v108, v4
  v_cvt_pk_bf16_f32 v104, v104, v248
  v_mul_f32 v105, v105, v1
  v_mfma_f32_16x16x32_bf16 v[16:19], a[16:19], v[216:219], v[16:19]
  s_mov_b32 m0, s46
  ds_read_b128 a[12:15], v251 offset:20304
  buffer_load_dwordx4 v254, s[12:15], m0 offen lds
  v_mul_f32 v248, v109, v5
  v_cvt_pk_bf16_f32 v105, v105, v248
  v_mul_f32 v106, v106, v2
  v_mul_f32 v248, v110, v6
  v_mfma_f32_16x16x32_bf16 v[16:19], a[20:23], v[224:227], v[16:19]
  ds_read_b128 a[16:19], v251 offset:20240
  v_cvt_pk_bf16_f32 v106, v106, v248
  v_mul_f32 v107, v107, v3
  v_mul_f32 v248, v111, v7
  v_cvt_pk_bf16_f32 v107, v107, v248
  v_mfma_f32_16x16x32_bf16 v[16:19], a[68:71], v[232:235], v[16:19]
  s_waitcnt vmcnt(9) lgkmcnt(7)
  ds_read_b128 a[20:23], v251 offset:20176
  v_mul_f32 v240, v112, v8
  v_mul_f32 v248, v116, v12
  v_cvt_pk_bf16_f32 v240, v240, v248
  v_mul_f32 v241, v113, v9
  v_mfma_f32_16x16x32_bf16 v[20:23], a[72:75], v[232:235], v[20:23]
  s_barrier
  ds_read_b128 a[24:27], v251 offset:26624
  v_mul_f32 v248, v117, v13
  v_cvt_pk_bf16_f32 v241, v241, v248
  v_mul_f32 v242, v114, v10
  v_mfma_f32_16x16x32_bf16 v[20:23], a[32:35], v[224:227], v[20:23]
  ds_read_b128 a[28:31], v251 offset:26688
  v_mul_f32 v248, v118, v14
  v_cvt_pk_bf16_f32 v242, v242, v248
  v_mul_f32 v243, v115, v11
  v_mul_f32 v248, v119, v15
  v_mfma_f32_16x16x32_bf16 v[20:23], a[36:39], v[216:219], v[20:23]
  s_mov_b32 m0, s44
  ds_read_b128 a[32:35], v251 offset:26752
  buffer_load_dwordx4 v254, s[28:31], s43 offen lds
  v_cvt_pk_bf16_f32 v243, v243, v248
  v_cndmask_b32_dpp v236, v104, v240, vcc quad_perm:[1,0,3,2] row_mask:0xf bank_mask:0xf
  v_mfma_f32_16x16x32_bf16 v[20:23], a[40:43], v[208:211], v[20:23]
  s_waitcnt lgkmcnt(7)
  ds_read_b64 a[60:61], v252 offset:26624
  v_cndmask_b32_dpp v237, v105, v241, vcc quad_perm:[1,0,3,2] row_mask:0xf bank_mask:0xf
  v_cndmask_b32_dpp v238, v106, v242, vcc quad_perm:[1,0,3,2] row_mask:0xf bank_mask:0xf
  v_cndmask_b32_dpp v239, v107, v243, vcc quad_perm:[1,0,3,2] row_mask:0xf bank_mask:0xf
  buffer_store_dwordx4 v[236:239], v249, s[24:27], s48 offen offset:0 sc1
  v_mfma_f32_16x16x32_bf16 v[24:27], a[44:47], v[208:211], v[24:27]
  ds_read_b64 a[64:65], v252 offset:26832
  v_mfma_f32_16x16x32_bf16 v[24:27], a[48:51], v[216:219], v[24:27]
  ds_read_b128 a[44:47], v251 offset:26960
  v_mfma_f32_16x16x32_bf16 v[24:27], a[0:3], v[224:227], v[24:27]
  ds_read_b128 a[48:51], v251 offset:26896
  v_mul_f32 v244, v120, v16
  v_mul_f32 v248, v124, v20
  v_mfma_f32_16x16x32_bf16 v[24:27], a[52:55], v[232:235], v[24:27]
  s_waitcnt lgkmcnt(7)
  ds_read_b128 a[0:3], v251 offset:26832
  v_cvt_pk_bf16_f32 v244, v244, v248
  v_mul_f32 v245, v121, v17
  v_mul_f32 v248, v125, v21
  v_mfma_f32_16x16x32_bf16 v[28:31], a[56:59], v[232:235], v[28:31]
  ds_read_b128 a[4:7], v251 offset:33280
  v_cvt_pk_bf16_f32 v245, v245, v248
  v_mul_f32 v246, v122, v18
  v_mfma_f32_16x16x32_bf16 v[28:31], a[12:15], v[224:227], v[28:31]
  ds_read_b128 a[8:11], v251 offset:33344
  v_mul_f32 v248, v126, v22
  v_cvt_pk_bf16_f32 v246, v246, v248
  v_mfma_f32_16x16x32_bf16 v[28:31], a[16:19], v[216:219], v[28:31]
  ds_read_b128 a[12:15], v251 offset:33408
  s_not_b64 vcc, vcc
  v_mul_f32 v247, v123, v19
  v_mfma_f32_16x16x32_bf16 v[28:31], a[20:23], v[208:211], v[28:31]
  s_waitcnt lgkmcnt(7)
  ds_read_b64 a[68:69], v252 offset:33280
  v_mul_f32 v248, v127, v23
  v_cvt_pk_bf16_f32 v247, v247, v248
  v_cndmask_b32_dpp v240, v240, v244, vcc quad_perm:[1,0,3,2] row_mask:0xf bank_mask:0xf
  v_mfma_f32_16x16x32_bf16 v[32:35], a[24:27], v[208:211], v[32:35]
  ds_read_b64 a[72:73], v252 offset:33488
  v_cndmask_b32_dpp v241, v241, v245, vcc quad_perm:[1,0,3,2] row_mask:0xf bank_mask:0xf
  v_cndmask_b32_dpp v242, v242, v246, vcc quad_perm:[1,0,3,2] row_mask:0xf bank_mask:0xf
  v_mfma_f32_16x16x32_bf16 v[32:35], a[28:31], v[216:219], v[32:35]
  ds_read_b128 a[24:27], v251 offset:33616
  v_cndmask_b32_dpp v243, v243, v247, vcc quad_perm:[1,0,3,2] row_mask:0xf bank_mask:0xf
  buffer_store_dwordx4 v[240:243], v253, s[24:27], s48 offen offset:128 sc1
  v_mfma_f32_16x16x32_bf16 v[32:35], a[32:35], v[224:227], v[32:35]
  ds_read_b128 a[28:31], v251 offset:33552
  v_mul_f32 v236, v128, v24
  v_mul_f32 v248, v132, v28
  v_mfma_f32_16x16x32_bf16 v[32:35], a[60:63], v[232:235], v[32:35]
  s_waitcnt lgkmcnt(7)
  ds_read_b128 a[32:35], v251 offset:33488
  v_cvt_pk_bf16_f32 v236, v236, v248
  v_mul_f32 v237, v129, v25
  v_mul_f32 v248, v133, v29
  v_mfma_f32_16x16x32_bf16 v[36:39], a[64:67], v[232:235], v[36:39]
  ds_read_b128 a[36:39], v251 offset:39936
  v_cvt_pk_bf16_f32 v237, v237, v248
  v_mul_f32 v238, v130, v26
  v_mfma_f32_16x16x32_bf16 v[36:39], a[44:47], v[224:227], v[36:39]
  ds_read_b128 a[40:43], v251 offset:40000
  v_mul_f32 v248, v134, v30
  v_cvt_pk_bf16_f32 v238, v238, v248
  s_not_b64 vcc, vcc
  v_mfma_f32_16x16x32_bf16 v[36:39], a[48:51], v[216:219], v[36:39]
  ds_read_b128 a[44:47], v251 offset:40064
  v_mul_f32 v239, v131, v27
  v_mul_f32 v248, v135, v31
  v_mfma_f32_16x16x32_bf16 v[36:39], a[0:3], v[208:211], v[36:39]
  s_waitcnt vmcnt(8) lgkmcnt(7)
  ds_read_b64 a[52:53], v252 offset:39936
  v_cvt_pk_bf16_f32 v239, v239, v248
  v_cndmask_b32_dpp v244, v244, v236, vcc quad_perm:[1,0,3,2] row_mask:0xf bank_mask:0xf
  v_mfma_f32_16x16x32_bf16 v[40:43], a[4:7], v[208:211], v[40:43]
  s_barrier
  ds_read_b64 a[56:57], v252 offset:40144
  v_add_u32 v252, v252, v255
  v_cndmask_b32_dpp v245, v245, v237, vcc quad_perm:[1,0,3,2] row_mask:0xf bank_mask:0xf
  v_cndmask_b32_dpp v246, v246, v238, vcc quad_perm:[1,0,3,2] row_mask:0xf bank_mask:0xf
  v_mfma_f32_16x16x32_bf16 v[40:43], a[8:11], v[216:219], v[40:43]
  ds_read_b128 a[4:7], v251 offset:40272
  v_cndmask_b32_dpp v247, v247, v239, vcc quad_perm:[1,0,3,2] row_mask:0xf bank_mask:0xf
  buffer_store_dwordx4 v[244:247], v249, s[24:27], s48 offen offset:128 sc1
  v_mfma_f32_16x16x32_bf16 v[40:43], a[12:15], v[224:227], v[40:43]
  ds_read_b128 a[8:11], v251 offset:40208
  v_mul_f32 v240, v136, v32
  v_mul_f32 v248, v140, v36
  v_mfma_f32_16x16x32_bf16 v[40:43], a[68:71], v[232:235], v[40:43]
  s_waitcnt lgkmcnt(7)
  ds_read_b128 a[12:15], v251 offset:40144
  v_add_u32 v251, 46592, v251
  v_cvt_pk_bf16_f32 v240, v240, v248
  v_mul_f32 v241, v137, v33
  v_mfma_f32_16x16x32_bf16 v[44:47], a[72:75], v[232:235], v[44:47]
  ds_read_b128 a[16:19], v251 offset:0
  v_mul_f32 v248, v141, v37
  v_cvt_pk_bf16_f32 v241, v241, v248
  v_mfma_f32_16x16x32_bf16 v[44:47], a[24:27], v[224:227], v[44:47]
  ds_read_b128 a[20:23], v251 offset:64
  v_mul_f32 v242, v138, v34
  v_mul_f32 v248, v142, v38
  v_cvt_pk_bf16_f32 v242, v242, v248
  v_mfma_f32_16x16x32_bf16 v[44:47], a[28:31], v[216:219], v[44:47]
  ds_read_b128 a[24:27], v251 offset:128
  s_not_b64 vcc, vcc
  v_mul_f32 v243, v139, v35
  v_mfma_f32_16x16x32_bf16 v[44:47], a[32:35], v[208:211], v[44:47]
  s_waitcnt lgkmcnt(7)
  ds_read_b64 a[60:61], v252 offset:0
  v_mul_f32 v248, v143, v39
  v_cvt_pk_bf16_f32 v243, v243, v248
  v_mfma_f32_16x16x32_bf16 v[48:51], a[36:39], v[208:211], v[48:51]
  ds_read_b64 a[64:65], v252 offset:208
  v_cndmask_b32_dpp v236, v236, v240, vcc quad_perm:[1,0,3,2] row_mask:0xf bank_mask:0xf
  v_cndmask_b32_dpp v237, v237, v241, vcc quad_perm:[1,0,3,2] row_mask:0xf bank_mask:0xf
  v_cndmask_b32_dpp v238, v238, v242, vcc quad_perm:[1,0,3,2] row_mask:0xf bank_mask:0xf
  v_mfma_f32_16x16x32_bf16 v[48:51], a[40:43], v[216:219], v[48:51]
  ds_read_b128 a[36:39], v251 offset:336
  v_cndmask_b32_dpp v239, v239, v243, vcc quad_perm:[1,0,3,2] row_mask:0xf bank_mask:0xf
  buffer_store_dwordx4 v[236:239], v253, s[24:27], s48 offen offset:256 sc1
  v_mfma_f32_16x16x32_bf16 v[48:51], a[44:47], v[224:227], v[48:51]
  ds_read_b128 a[40:43], v251 offset:272
  v_mul_f32 v244, v144, v40
  v_mul_f32 v248, v148, v44
  v_mfma_f32_16x16x32_bf16 v[48:51], a[52:55], v[232:235], v[48:51]
  s_waitcnt lgkmcnt(7)
  ds_read_b128 a[44:47], v251 offset:208
  v_cvt_pk_bf16_f32 v244, v244, v248
  v_mul_f32 v245, v145, v41
  v_mul_f32 v248, v149, v45
  v_mfma_f32_16x16x32_bf16 v[52:55], a[56:59], v[232:235], v[52:55]
  ds_read_b128 a[48:51], v251 offset:6656
  v_cvt_pk_bf16_f32 v245, v245, v248
  v_mul_f32 v246, v146, v42
  v_mfma_f32_16x16x32_bf16 v[52:55], a[4:7], v[224:227], v[52:55]
  ds_read_b128 a[0:3], v251 offset:6720
  v_mul_f32 v248, v150, v46
  v_cvt_pk_bf16_f32 v246, v246, v248
  v_mfma_f32_16x16x32_bf16 v[52:55], a[8:11], v[216:219], v[52:55]
  ds_read_b128 a[4:7], v251 offset:6784
  s_not_b64 vcc, vcc
  v_mul_f32 v247, v147, v43
  v_mfma_f32_16x16x32_bf16 v[52:55], a[12:15], v[208:211], v[52:55]
  s_waitcnt vmcnt(6) lgkmcnt(7)
  ds_read_b64 a[68:69], v252 offset:6656
  v_mul_f32 v248, v151, v47
  v_cvt_pk_bf16_f32 v247, v247, v248
  v_cndmask_b32_dpp v240, v240, v244, vcc quad_perm:[1,0,3,2] row_mask:0xf bank_mask:0xf
  v_mfma_f32_16x16x32_bf16 v[56:59], a[16:19], v[208:211], v[56:59]
  s_barrier
  ds_read_b64 a[72:73], v252 offset:6864
  v_cndmask_b32_dpp v241, v241, v245, vcc quad_perm:[1,0,3,2] row_mask:0xf bank_mask:0xf
  v_cndmask_b32_dpp v242, v242, v246, vcc quad_perm:[1,0,3,2] row_mask:0xf bank_mask:0xf
  v_mfma_f32_16x16x32_bf16 v[56:59], a[20:23], v[216:219], v[56:59]
  ds_read_b128 a[16:19], v251 offset:6992
  v_cndmask_b32_dpp v243, v243, v247, vcc quad_perm:[1,0,3,2] row_mask:0xf bank_mask:0xf
  buffer_store_dwordx4 v[240:243], v249, s[24:27], s48 offen offset:256 sc1
  v_mfma_f32_16x16x32_bf16 v[56:59], a[24:27], v[224:227], v[56:59]
  ds_read_b128 a[20:23], v251 offset:6928
  v_mul_f32 v236, v152, v48
  v_mul_f32 v248, v156, v52
  v_mfma_f32_16x16x32_bf16 v[56:59], a[60:63], v[232:235], v[56:59]
  s_waitcnt lgkmcnt(7)
  ds_read_b128 a[24:27], v251 offset:6864
  v_cvt_pk_bf16_f32 v236, v236, v248
  v_mul_f32 v237, v153, v49
  v_mul_f32 v248, v157, v53
  v_mfma_f32_16x16x32_bf16 v[60:63], a[64:67], v[232:235], v[60:63]
  ds_read_b128 a[28:31], v251 offset:13312
  v_cvt_pk_bf16_f32 v237, v237, v248
  v_mul_f32 v238, v154, v50
  v_mfma_f32_16x16x32_bf16 v[60:63], a[36:39], v[224:227], v[60:63]
  ds_read_b128 a[32:35], v251 offset:13376
  v_mul_f32 v248, v158, v54
  v_cvt_pk_bf16_f32 v238, v238, v248
  v_mfma_f32_16x16x32_bf16 v[60:63], a[40:43], v[216:219], v[60:63]
  ds_read_b128 a[36:39], v251 offset:13440
  s_not_b64 vcc, vcc
  v_mul_f32 v239, v155, v51
  v_mfma_f32_16x16x32_bf16 v[60:63], a[44:47], v[208:211], v[60:63]
  s_waitcnt lgkmcnt(7)
  ds_read_b64 a[52:53], v252 offset:13312
  v_mul_f32 v248, v159, v55
  v_cvt_pk_bf16_f32 v239, v239, v248
  v_cndmask_b32_dpp v244, v244, v236, vcc quad_perm:[1,0,3,2] row_mask:0xf bank_mask:0xf
  v_mfma_f32_16x16x32_bf16 v[64:67], a[48:51], v[208:211], v[64:67]
  ds_read_b64 a[56:57], v252 offset:13520
  v_cndmask_b32_dpp v245, v245, v237, vcc quad_perm:[1,0,3,2] row_mask:0xf bank_mask:0xf
  v_cndmask_b32_dpp v246, v246, v238, vcc quad_perm:[1,0,3,2] row_mask:0xf bank_mask:0xf
  v_mfma_f32_16x16x32_bf16 v[64:67], a[0:3], v[216:219], v[64:67]
  ds_read_b128 a[48:51], v251 offset:13648
  v_cndmask_b32_dpp v247, v247, v239, vcc quad_perm:[1,0,3,2] row_mask:0xf bank_mask:0xf
  buffer_store_dwordx4 v[244:247], v253, s[24:27], s48 offen offset:384 sc1
  v_mfma_f32_16x16x32_bf16 v[64:67], a[4:7], v[224:227], v[64:67]
  ds_read_b128 a[0:3], v251 offset:13584
  v_mul_f32 v240, v160, v56
  v_mul_f32 v248, v164, v60
  v_mfma_f32_16x16x32_bf16 v[64:67], a[68:71], v[232:235], v[64:67]
  s_waitcnt lgkmcnt(7)
  ds_read_b128 a[4:7], v251 offset:13520
  v_cvt_pk_bf16_f32 v240, v240, v248
  v_mul_f32 v241, v161, v57
  v_mul_f32 v248, v165, v61
  v_mfma_f32_16x16x32_bf16 v[68:71], a[72:75], v[232:235], v[68:71]
  ds_read_b128 a[8:11], v251 offset:19968
  v_cvt_pk_bf16_f32 v241, v241, v248
  v_mul_f32 v242, v162, v58
  v_mfma_f32_16x16x32_bf16 v[68:71], a[16:19], v[224:227], v[68:71]
  ds_read_b128 a[12:15], v251 offset:20032
  v_mul_f32 v248, v166, v62
  v_cvt_pk_bf16_f32 v242, v242, v248
  v_mfma_f32_16x16x32_bf16 v[68:71], a[20:23], v[216:219], v[68:71]
  ds_read_b128 a[16:19], v251 offset:20096
  s_not_b64 vcc, vcc
  v_mul_f32 v243, v163, v59
  v_mfma_f32_16x16x32_bf16 v[68:71], a[24:27], v[208:211], v[68:71]
  s_waitcnt vmcnt(6) lgkmcnt(7)
  ds_read_b64 a[60:61], v252 offset:19968
  v_mul_f32 v248, v167, v63
  v_cvt_pk_bf16_f32 v243, v243, v248
  v_cndmask_b32_dpp v236, v236, v240, vcc quad_perm:[1,0,3,2] row_mask:0xf bank_mask:0xf
  v_mfma_f32_16x16x32_bf16 v[72:75], a[28:31], v[208:211], v[72:75]
  s_barrier
  ds_read_b64 a[64:65], v252 offset:20176
  v_cndmask_b32_dpp v237, v237, v241, vcc quad_perm:[1,0,3,2] row_mask:0xf bank_mask:0xf
  v_cndmask_b32_dpp v238, v238, v242, vcc quad_perm:[1,0,3,2] row_mask:0xf bank_mask:0xf
  v_mfma_f32_16x16x32_bf16 v[72:75], a[32:35], v[216:219], v[72:75]
  ds_read_b128 a[28:31], v251 offset:20304
  v_cndmask_b32_dpp v239, v239, v243, vcc quad_perm:[1,0,3,2] row_mask:0xf bank_mask:0xf
  buffer_store_dwordx4 v[236:239], v249, s[24:27], s48 offen offset:384 sc1
  v_mfma_f32_16x16x32_bf16 v[72:75], a[36:39], v[224:227], v[72:75]
  ds_read_b128 a[32:35], v251 offset:20240
  v_mul_f32 v244, v168, v64
  v_mul_f32 v248, v172, v68
  v_mfma_f32_16x16x32_bf16 v[72:75], a[52:55], v[232:235], v[72:75]
  s_waitcnt lgkmcnt(7)
  ds_read_b128 a[36:39], v251 offset:20176
  v_cvt_pk_bf16_f32 v244, v244, v248
  v_mul_f32 v245, v169, v65
  v_mul_f32 v248, v173, v69
  v_mfma_f32_16x16x32_bf16 v[76:79], a[56:59], v[232:235], v[76:79]
  ds_read_b128 a[40:43], v251 offset:26624
  v_cvt_pk_bf16_f32 v245, v245, v248
  v_mul_f32 v246, v170, v66
  v_mfma_f32_16x16x32_bf16 v[76:79], a[48:51], v[224:227], v[76:79]
  ds_read_b128 a[44:47], v251 offset:26688
  v_mul_f32 v248, v174, v70
  v_cvt_pk_bf16_f32 v246, v246, v248
  v_mfma_f32_16x16x32_bf16 v[76:79], a[0:3], v[216:219], v[76:79]
  ds_read_b128 a[48:51], v251 offset:26752
  s_not_b64 vcc, vcc
  v_mul_f32 v247, v171, v67
  v_mfma_f32_16x16x32_bf16 v[76:79], a[4:7], v[208:211], v[76:79]
  s_waitcnt lgkmcnt(7)
  ds_read_b64 a[68:69], v252 offset:26624
  v_mul_f32 v248, v175, v71
  v_cvt_pk_bf16_f32 v247, v247, v248
  v_cndmask_b32_dpp v240, v240, v244, vcc quad_perm:[1,0,3,2] row_mask:0xf bank_mask:0xf
  v_mfma_f32_16x16x32_bf16 v[80:83], a[8:11], v[208:211], v[80:83]
  ds_read_b64 a[72:73], v252 offset:26832
  v_cndmask_b32_dpp v241, v241, v245, vcc quad_perm:[1,0,3,2] row_mask:0xf bank_mask:0xf
  v_cndmask_b32_dpp v242, v242, v246, vcc quad_perm:[1,0,3,2] row_mask:0xf bank_mask:0xf
  v_mfma_f32_16x16x32_bf16 v[80:83], a[12:15], v[216:219], v[80:83]
  ds_read_b128 a[8:11], v251 offset:26960
  v_cndmask_b32_dpp v243, v243, v247, vcc quad_perm:[1,0,3,2] row_mask:0xf bank_mask:0xf
  buffer_store_dwordx4 v[240:243], v253, s[24:27], s48 offen offset:512 sc1
  v_mfma_f32_16x16x32_bf16 v[80:83], a[16:19], v[224:227], v[80:83]
  ds_read_b128 a[12:15], v251 offset:26896
  v_mul_f32 v236, v176, v72
  v_mul_f32 v248, v180, v76
  v_mfma_f32_16x16x32_bf16 v[80:83], a[60:63], v[232:235], v[80:83]
  s_waitcnt lgkmcnt(7)
  ds_read_b128 a[16:19], v251 offset:26832
  v_cvt_pk_bf16_f32 v236, v236, v248
  v_mul_f32 v237, v177, v73
  v_mul_f32 v248, v181, v77
  v_mfma_f32_16x16x32_bf16 v[84:87], a[64:67], v[232:235], v[84:87]
  ds_read_b128 a[20:23], v251 offset:33280
  v_cvt_pk_bf16_f32 v237, v237, v248
  v_mul_f32 v238, v178, v74
  v_mfma_f32_16x16x32_bf16 v[84:87], a[28:31], v[224:227], v[84:87]
  ds_read_b128 a[24:27], v251 offset:33344
  v_mul_f32 v248, v182, v78
  v_cvt_pk_bf16_f32 v238, v238, v248
  v_mfma_f32_16x16x32_bf16 v[84:87], a[32:35], v[216:219], v[84:87]
  ds_read_b128 a[28:31], v251 offset:33408
  s_not_b64 vcc, vcc
  v_mul_f32 v239, v179, v75
  v_mfma_f32_16x16x32_bf16 v[84:87], a[36:39], v[208:211], v[84:87]
  s_waitcnt lgkmcnt(7)
  ds_read_b64 a[52:53], v252 offset:33280
  v_mul_f32 v248, v183, v79
  v_cvt_pk_bf16_f32 v239, v239, v248
  v_cndmask_b32_dpp v244, v244, v236, vcc quad_perm:[1,0,3,2] row_mask:0xf bank_mask:0xf
  v_mfma_f32_16x16x32_bf16 v[88:91], a[40:43], v[208:211], v[88:91]
  ds_read_b64 a[56:57], v252 offset:33488
  v_cndmask_b32_dpp v245, v245, v237, vcc quad_perm:[1,0,3,2] row_mask:0xf bank_mask:0xf
  v_cndmask_b32_dpp v246, v246, v238, vcc quad_perm:[1,0,3,2] row_mask:0xf bank_mask:0xf
  v_mfma_f32_16x16x32_bf16 v[88:91], a[44:47], v[216:219], v[88:91]
  ds_read_b128 a[40:43], v251 offset:33616
  v_cndmask_b32_dpp v247, v247, v239, vcc quad_perm:[1,0,3,2] row_mask:0xf bank_mask:0xf
  buffer_store_dwordx4 v[244:247], v249, s[24:27], s48 offen offset:512 sc1
  v_mfma_f32_16x16x32_bf16 v[88:91], a[48:51], v[224:227], v[88:91]
  ds_read_b128 a[44:47], v251 offset:33552
  v_mul_f32 v240, v184, v80
  v_mul_f32 v248, v188, v84
  v_mfma_f32_16x16x32_bf16 v[88:91], a[68:71], v[232:235], v[88:91]
  s_waitcnt lgkmcnt(7)
  ds_read_b128 a[48:51], v251 offset:33488
  v_cvt_pk_bf16_f32 v240, v240, v248
  v_mul_f32 v241, v185, v81
  v_mul_f32 v248, v189, v85
  v_mfma_f32_16x16x32_bf16 v[92:95], a[72:75], v[232:235], v[92:95]
  v_cvt_pk_bf16_f32 v241, v241, v248
  v_mul_f32 v242, v186, v82
  v_mfma_f32_16x16x32_bf16 v[92:95], a[8:11], v[224:227], v[92:95]
  v_mul_f32 v248, v190, v86
  v_cvt_pk_bf16_f32 v242, v242, v248
  v_mfma_f32_16x16x32_bf16 v[92:95], a[12:15], v[216:219], v[92:95]
  s_not_b64 vcc, vcc
  v_mul_f32 v243, v187, v83
  v_mfma_f32_16x16x32_bf16 v[92:95], a[16:19], v[208:211], v[92:95]
  s_waitcnt lgkmcnt(4)
  v_mul_f32 v248, v191, v87
  v_cvt_pk_bf16_f32 v243, v243, v248
  v_cndmask_b32_dpp v236, v236, v240, vcc quad_perm:[1,0,3,2] row_mask:0xf bank_mask:0xf
  v_mfma_f32_16x16x32_bf16 v[96:99], a[20:23], v[208:211], v[96:99]
  v_cndmask_b32_dpp v237, v237, v241, vcc quad_perm:[1,0,3,2] row_mask:0xf bank_mask:0xf
  v_cndmask_b32_dpp v238, v238, v242, vcc quad_perm:[1,0,3,2] row_mask:0xf bank_mask:0xf
  v_mfma_f32_16x16x32_bf16 v[96:99], a[24:27], v[216:219], v[96:99]
  v_cndmask_b32_dpp v239, v239, v243, vcc quad_perm:[1,0,3,2] row_mask:0xf bank_mask:0xf
  buffer_store_dwordx4 v[236:239], v253, s[24:27], s48 offen offset:640 sc1
  v_mfma_f32_16x16x32_bf16 v[96:99], a[28:31], v[224:227], v[96:99]
  v_mul_f32 v244, v192, v88
  v_mul_f32 v248, v196, v92
  v_cvt_pk_bf16_f32 v244, v244, v248
  v_mfma_f32_16x16x32_bf16 v[96:99], a[52:55], v[232:235], v[96:99]
  s_waitcnt lgkmcnt(0)
  v_mul_f32 v245, v193, v89
  v_mul_f32 v248, v197, v93
  v_cvt_pk_bf16_f32 v245, v245, v248
  v_mfma_f32_16x16x32_bf16 v[100:103], a[56:59], v[232:235], v[100:103]
  v_mul_f32 v246, v194, v90
  v_mul_f32 v248, v198, v94
  v_cvt_pk_bf16_f32 v246, v246, v248
  v_mfma_f32_16x16x32_bf16 v[100:103], a[40:43], v[224:227], v[100:103]
  s_not_b64 vcc, vcc
  v_mul_f32 v247, v195, v91
  v_mul_f32 v248, v199, v95
  v_mfma_f32_16x16x32_bf16 v[100:103], a[44:47], v[216:219], v[100:103]
  v_cvt_pk_bf16_f32 v247, v247, v248
  v_cndmask_b32_dpp v240, v240, v244, vcc quad_perm:[1,0,3,2] row_mask:0xf bank_mask:0xf
  v_cndmask_b32_dpp v241, v241, v245, vcc quad_perm:[1,0,3,2] row_mask:0xf bank_mask:0xf
  v_mfma_f32_16x16x32_bf16 v[100:103], a[48:51], v[208:211], v[100:103]
  v_cndmask_b32_dpp v242, v242, v246, vcc quad_perm:[1,0,3,2] row_mask:0xf bank_mask:0xf
  v_cndmask_b32_dpp v243, v243, v247, vcc quad_perm:[1,0,3,2] row_mask:0xf bank_mask:0xf
  buffer_store_dwordx4 v[240:243], v249, s[24:27], s48 offen offset:640 sc1
  s_nop 5
  v_mul_f32 v236, v200, v96
  v_mul_f32 v248, v204, v100
  v_cvt_pk_bf16_f32 v236, v236, v248
  v_mul_f32 v237, v201, v97
  v_mul_f32 v248, v205, v101
  v_cvt_pk_bf16_f32 v237, v237, v248
  v_mul_f32 v238, v202, v98
  v_mul_f32 v248, v206, v102
  v_cvt_pk_bf16_f32 v238, v238, v248
  s_not_b64 vcc, vcc
  v_mul_f32 v239, v203, v99
  v_mul_f32 v248, v207, v103
  v_cvt_pk_bf16_f32 v239, v239, v248
  v_cndmask_b32_dpp v244, v244, v236, vcc quad_perm:[1,0,3,2] row_mask:0xf bank_mask:0xf
  v_cndmask_b32_dpp v245, v245, v237, vcc quad_perm:[1,0,3,2] row_mask:0xf bank_mask:0xf
  v_cndmask_b32_dpp v246, v246, v238, vcc quad_perm:[1,0,3,2] row_mask:0xf bank_mask:0xf
  v_cndmask_b32_dpp v247, v247, v239, vcc quad_perm:[1,0,3,2] row_mask:0xf bank_mask:0xf
  buffer_store_dwordx4 v[244:247], v253, s[24:27], s48 offen offset:768 sc1
  v_cndmask_b32 v104, v236, v104, vcc
  v_cndmask_b32 v105, v237, v105, vcc
  v_cndmask_b32 v106, v238, v106, vcc
  v_cndmask_b32 v107, v239, v107, vcc
  buffer_store_dwordx4 v[104:107], v253, s[24:27], s48 offen offset:0 sc1
L_end:
  s_endpgm
  s_endpgm
  s_endpgm
  s_endpgm
  s_endpgm
  s_endpgm
  s_endpgm
  s_endpgm
  s_endpgm
  s_endpgm
  s_endpgm
  s_endpgm
  s_endpgm
  s_endpgm
  s_endpgm
  s_endpgm
  s_endpgm
  s_endpgm
  s_endpgm
  s_endpgm
  s_endpgm
  s_endpgm
  s_endpgm
  s_endpgm
  s_endpgm
  s_endpgm
  s_endpgm
  s_endpgm
  s_endpgm
  s_endpgm
  s_endpgm
  s_endpgm
  s_endpgm
  s_endpgm
  s_endpgm
  s_endpgm
  s_endpgm
  s_endpgm
  s_endpgm
  s_endpgm
  s_endpgm
  s_endpgm
  s_endpgm
  s_endpgm
  s_endpgm
  s_endpgm
  s_endpgm
  s_endpgm
  s_endpgm
  s_endpgm
  s_endpgm
  s_endpgm
  s_endpgm
  s_endpgm
  s_endpgm
  s_endpgm
  s_endpgm
  s_endpgm
  s_endpgm
  s_endpgm
  s_endpgm
  s_endpgm
  s_endpgm
  s_endpgm
  s_endpgm
  s_endpgm
  s_endpgm
  s_endpgm
  s_endpgm
  s_endpgm
  s_endpgm
  s_endpgm
  s_endpgm
  s_endpgm
  s_endpgm
  s_endpgm
  s_endpgm
  s_endpgm
  s_endpgm
  s_endpgm
  s_endpgm
  s_endpgm
  s_endpgm
  s_endpgm
  s_endpgm
  s_endpgm
  s_endpgm
  s_endpgm
  s_endpgm
  s_endpgm
  s_endpgm
  s_endpgm
  s_endpgm
  s_endpgm
  s_endpgm
  s_endpgm
  s_endpgm
  s_endpgm
  s_endpgm
  s_endpgm
  s_endpgm
  s_endpgm
  s_endpgm
  s_endpgm
  s_endpgm
  s_endpgm
  s_endpgm
  s_endpgm
  s_endpgm
  s_endpgm
  s_endpgm
  s_endpgm
  s_endpgm
  s_endpgm
  s_endpgm
  s_endpgm
  s_endpgm
  s_endpgm
  s_endpgm
  s_endpgm
  s_endpgm
  s_endpgm
  s_endpgm
  s_endpgm
  s_endpgm
  s_endpgm
  s_endpgm
  s_endpgm
  s_endpgm
  s_endpgm
  s_endpgm
  s_endpgm
  s_endpgm
  s_endpgm
  s_endpgm
  s_endpgm
  s_endpgm
  s_endpgm
  s_endpgm
  s_endpgm
  s_endpgm
  s_endpgm
  s_endpgm
  s_endpgm
  s_endpgm
  s_endpgm
  s_endpgm
  s_endpgm
  s_endpgm
  s_endpgm
  s_endpgm
  s_endpgm
  s_endpgm
  s_endpgm
  s_endpgm
  s_endpgm
  s_endpgm
  s_endpgm
  s_endpgm
  s_endpgm
  s_endpgm
  s_endpgm
  s_endpgm
  s_endpgm
  s_endpgm
  s_endpgm
  s_endpgm
  s_endpgm
  s_endpgm
  s_endpgm
  s_endpgm
  s_endpgm
  s_endpgm
  s_endpgm
  s_endpgm
  s_endpgm
  s_endpgm
  s_endpgm
  s_endpgm
  s_endpgm
  s_endpgm
  s_endpgm
  s_endpgm
  s_endpgm
  s_endpgm
  s_endpgm
  s_endpgm
  s_endpgm
  s_endpgm
  s_endpgm
  s_endpgm
  s_endpgm
  s_endpgm
  s_endpgm
  s_endpgm
  s_endpgm
  s_endpgm
  s_endpgm
  s_endpgm
  s_endpgm
  s_endpgm
  s_endpgm
  s_endpgm
  s_endpgm
  s_endpgm
  s_endpgm
  s_endpgm
  s_endpgm
  s_endpgm
  s_endpgm
  s_endpgm
  s_endpgm
  s_endpgm
  s_endpgm
  s_endpgm
  s_endpgm
  s_endpgm
  s_endpgm
  s_endpgm
  s_endpgm
  s_endpgm
  s_endpgm
  s_endpgm
  s_endpgm
  s_endpgm
  s_endpgm
  s_endpgm
  s_endpgm
  s_endpgm
  s_endpgm
  s_endpgm
  s_endpgm
  s_endpgm
  s_endpgm
  s_endpgm
  s_endpgm
  s_endpgm
  s_endpgm
  s_endpgm
  s_endpgm
  s_endpgm
  s_endpgm
  s_endpgm
  s_endpgm
  s_endpgm
  s_endpgm
  s_endpgm
  s_endpgm
  s_endpgm
  s_endpgm
  s_endpgm
  s_endpgm
  s_endpgm
  s_endpgm
  s_endpgm
  s_endpgm
  s_endpgm
L_pad:
.section .rodata,"a"
.p2align 6
.amdhsa_kernel standalone__cross_network_dcn_v2__recsys_kernel
  .amdhsa_next_free_vgpr 344
  .amdhsa_next_free_sgpr 102
  .amdhsa_accum_offset 256
  .amdhsa_group_segment_fixed_size 0
  .amdhsa_kernarg_size 56
  .amdhsa_user_sgpr_count 2
  .amdhsa_user_sgpr_kernarg_segment_ptr 1
  .amdhsa_system_sgpr_workgroup_id_x 1
.end_amdhsa_kernel
```
